```python
import torch

def _softmax(x, axis=-1):
    return torch.softmax(x, dim=axis)
def _gelu(x):
    return torch.nn.functional.gelu(x, approximate="tanh")
def _silu(x):
    return torch.nn.functional.silu(x)
def _sigmoid(x):
    return torch.sigmoid(x)
def _layernorm(x, axis=-1, eps=1e-5):
    m = x.mean(dim=axis, keepdim=True)
    v = x.var(dim=axis, keepdim=True, unbiased=False)
    return (x - m) / torch.sqrt(v + eps)
def _scatter_add(tgt, idx, src, axis=0):
    return tgt.clone().index_add_(axis, idx, src)
def _segment_sum(src, seg, n):
    out = torch.zeros((n,) + src.shape[1:], dtype=src.dtype)
    return out.index_add_(0, seg, src)
def _pad(x, pw):
    flat = tuple(v for pair in reversed(pw) for v in pair)
    return torch.nn.functional.pad(x, flat)

kernel_name = 'sequential_preLN__ssm_conv_s4d__dense_activation_gelu__prompt'

def setup_inputs():

    _w = (lambda a: (lambda t: t.to(torch.bfloat16) if t.is_floating_point() else t)(torch.as_tensor(a)))
    def _A_setup():
        Bsz, L, D, N = 1, 2048, 512, 128
        return {
            "u": _w((lambda *s: torch.randn(*s, dtype=torch.bfloat16) * 0.05)(Bsz, L, D)),
            "log_A_real": _w((lambda *s: torch.randn(*s, dtype=torch.bfloat16) * 6.4)(D, N) * 0.5),
            "A_imag": _w((lambda *s: torch.randn(*s, dtype=torch.bfloat16) * 0.05)(D, N) * 3.14),
            "C_real": _w((lambda *s: torch.randn(*s, dtype=torch.bfloat16) * 0.05)(D, N) / N ** 0.5),
            "C_imag": _w((lambda *s: torch.randn(*s, dtype=torch.bfloat16) * 0.05)(D, N) / N ** 0.5),
            "log_dt": _w((lambda *s: torch.randn(*s, dtype=torch.bfloat16) * 0.05)(D) * 0.5 - 4.0),
            "D_skip": _w((lambda *s: torch.randn(*s, dtype=torch.bfloat16) * 0.05)(D)),
        }
    _A_in = _A_setup()

    def _B_setup():
        B, S, D, F = 1, 2048, 512, 1792
        return {
            "x": _w((lambda *s: torch.randn(*s, dtype=torch.bfloat16) * 0.05)(B, S, D)),
            "w1": _w((lambda *s: torch.randn(*s, dtype=torch.bfloat16) * 0.8)(D, F) * (D ** -0.5)),
            "b1": _w((lambda *s: torch.randn(*s, dtype=torch.bfloat16) * 12.8)(F) * 0.01),
            "w2": _w((lambda *s: torch.randn(*s, dtype=torch.bfloat16) * 0.4)(F, D) * (F ** -0.5)),
            "b2": _w((lambda *s: torch.randn(*s, dtype=torch.bfloat16) * 6.4)(D) * 0.01),
        }
    _B_in = _B_setup()

    return {
        "A_u": _A_in["u"],
        "A_log_A_real": _A_in["log_A_real"],
        "A_A_imag": _A_in["A_imag"],
        "A_C_real": _A_in["C_real"],
        "A_C_imag": _A_in["C_imag"],
        "A_log_dt": _A_in["log_dt"],
        "A_D_skip": _A_in["D_skip"],
        "B_x": _B_in["x"],
        "B_w1": _B_in["w1"],
        "B_b1": _B_in["b1"],
        "B_w2": _B_in["w2"],
        "B_b2": _B_in["b2"],
    }

def reference(A_u, A_log_A_real, A_A_imag, A_C_real, A_C_imag, A_log_dt, A_D_skip, B_x, B_w1, B_b1, B_w2, B_b2):
    def _A_ref(u, log_A_real, A_imag, C_real, C_imag, log_dt, D_skip):
        L = u.shape[1]
        dt = torch.exp(log_dt)
        A = -torch.exp(log_A_real) + 1j * A_imag
        C = (C_real + 1j * C_imag) * dt[:, None]
        pos = (lambda x, dt: x.to(dt))(torch.arange(L), log_dt.dtype)
        P = torch.exp((A * dt[:, None])[:, :, None] * pos[None, None, :])
        K = 2.0 * torch.einsum("dn,dnl->dl", C, P).real
        L2 = 2 * L
        u_t = (lambda x, *d: x.permute(*d))(u, 0, 2, 1)
        Kf = (lambda x, *a, **k: torch.fft.rfft(x.float(), *a, **k))(K, L2)
        Uf = (lambda x, *a, **k: torch.fft.rfft(x.float(), *a, **k))(u_t, L2)
        y = (lambda x, *a, **k: torch.fft.irfft(x, *a, **k).to(torch.bfloat16))(Uf * Kf[None, :, :], L2)[:, :, :L]
        y = (lambda x, *d: x.permute(*d))(y, 0, 2, 1)
        return y + u * D_skip[None, None, :]

    def _B_ref(x, w1, b1, w2, b2):
        h = torch.einsum("bsd,df->bsf", x, w1) + b1
        h = _gelu(h)
        return torch.einsum("bsf,fd->bsd", h, w2) + b2

    x = A_u
    h = x + _A_ref(_layernorm(x, axis=-1), A_log_A_real, A_A_imag, A_C_real, A_C_imag, A_log_dt, A_D_skip)
    h2 = h + _B_ref(_layernorm(h, axis=-1), B_w1, B_b1, B_w2, B_b2)
    return h2
```

```asm
; @launch grid=(256,1,1) block=(256,1,1) lds=163840
.amdgcn_target "amdgcn-amd-amdhsa--gfx950"
.text
.globl sequential_preLN__ssm_conv_s4d__dense_activation_gelu__prompt_kernel
.p2align 8
.type sequential_preLN__ssm_conv_s4d__dense_activation_gelu__prompt_kernel,@function
sequential_preLN__ssm_conv_s4d__dense_activation_gelu__prompt_kernel:
    s_cmp_ge_u32 s2, 256
    s_cbranch_scc1 Lexit_1
    s_load_dwordx16 s[20:35], s[0:1], 0
    s_load_dwordx8 s[36:43], s[0:1], 64
    s_load_dwordx4 s[44:47], s[0:1], 96
    s_load_dwordx2 s[48:49], s[0:1], 112
    s_and_b32 s16, s2, 7
    s_lshr_b32 s17, s2, 3
    s_lshl_b32 s19, s16, 5
    s_add_u32 s19, s19, s17
    v_lshrrev_b32 v1, 6, v0
    v_and_b32 v2, 63, v0
    v_readfirstlane_b32 s18, v1
    s_lshl_b32 s51, s16, 1
    s_lshr_b32 s53, s17, 4
    s_add_u32 s51, s51, s53
    s_and_b32 s52, s17, 15
    s_getpc_b64 s[54:55]
Lcp_pc:
    s_mul_i32 s56, s18, 56
    v_min_u32 v36, 55, v2
    v_add_u32 v36, s56, v36
    v_lshlrev_b32 v36, 7, v36
    v_min_u32 v36, (Lkernel_end-Lcp_pc-4), v36
    v_and_b32 v36, 0xfffffffc, v36
    v_mov_b32 v37, s55
    v_add_co_u32 v36, vcc, s54, v36
    s_nop 1
    v_addc_co_u32 v37, vcc, 0, v37, vcc
    s_mov_b32 exec_lo, 0xffffffff
    s_mov_b32 exec_hi, 0xffffff
    global_load_dword v253, v[36:37], off
    s_mov_b64 exec, -1
    s_lshl_b32 s53, s19, 13
    v_lshlrev_b32 v3, 2, v0
    v_add_u32 v3, s53, v3
    v_add_u32 v4, 4096, v3
    v_lshlrev_b32 v5, 11, v1
    v_lshlrev_b32 v6, 4, v2
    v_add3_u32 v5, v5, v6, s53
    s_lshl_b32 s54, s19, 9
    v_lshlrev_b32 v7, 1, v0
    v_add_u32 v7, s54, v7
    v_lshrrev_b32 v29, 7, v0
    v_lshlrev_b32 v29, 1, v29
    s_lshl_b32 s54, s19, 2
    v_add_u32 v29, s54, v29
    s_waitcnt lgkmcnt(0)
    global_load_dword v16, v3, s[20:21] offset:0
    global_load_dword v17, v3, s[20:21] offset:1024
    global_load_dword v18, v3, s[20:21] offset:2048
    global_load_dword v19, v3, s[20:21] offset:3072
    global_load_dword v20, v4, s[20:21] offset:0
    global_load_dword v21, v4, s[20:21] offset:1024
    global_load_dword v22, v4, s[20:21] offset:2048
    global_load_dword v23, v4, s[20:21] offset:3072
    global_load_dwordx4 v[8:11], v5, s[20:21]
    global_load_dwordx4 v[12:15], v5, s[20:21] offset:1024
    global_load_ushort v24, v29, s[30:31]
    global_load_ushort v25, v7, s[22:23]
    global_load_ushort v26, v7, s[24:25]
    global_load_ushort v27, v7, s[26:27]
    global_load_ushort v28, v7, s[28:29]
    s_mul_i32 s54, s52, 224
    v_min_u32 v34, 55, v2
    v_lshlrev_b32 v34, 2, v34
    v_add_u32 v34, s54, v34
    global_load_dword v245, v34, s[38:39]
    s_lshl_b32 s53, s19, 2
    v_mov_b32 v35, s53
    global_load_dword v246, v35, s[32:33]
    v_mov_b32 v200, 0
    v_mov_b32 v201, 0
    v_mov_b32 v202, 0
    v_mov_b32 v203, 0
    s_mul_i32 s55, s16, 19
    s_add_u32 s55, s55, s17
    s_mul_i32 s55, s55, 3
    s_add_u32 s55, s55, s18
    s_sub_u32 s55, s55, 1
    s_mov_b32 s70, 0
    s_cmp_lt_u32 s17, 19
    s_cbranch_scc0 La_now2_2
    s_cmp_eq_u32 s18, 0
    s_cbranch_scc1 La_now2_2
    s_cmp_lt_u32 s55, 448
    s_cbranch_scc0 La_now2_2
    s_mov_b32 s70, 1
    s_lshr_b32 s71, s55, 3
    s_and_b32 s72, s55, 7
    s_mul_i32 s56, s71, 4682
    s_lshr_b32 s56, s56, 16
    s_mul_i32 s57, s56, 14
    s_sub_u32 s57, s71, s57
    s_lshl_b32 s56, s56, 2
    s_mul_i32 s58, s57, 21846
    s_lshr_b32 s58, s58, 16
    s_mul_i32 s59, s58, 3
    s_sub_u32 s59, s57, s59
    s_add_u32 s58, s58, s56
    s_mul_i32 s58, s58, 112
    s_lshl_b32 s59, s59, 5
    s_add_u32 s58, s58, s59
    s_add_u32 s59, s58, 16
    s_sub_u32 s60, s57, 12
    s_lshl_b32 s60, s60, 1
    s_add_u32 s60, s60, s56
    s_mul_i32 s60, s60, 112
    s_add_u32 s60, s60, 96
    s_add_u32 s61, s60, 112
    s_cmp_lt_u32 s57, 12
    s_cselect_b32 s15, 0, 1
    s_cselect_b32 s58, s58, s60
    s_cselect_b32 s59, s59, s61
    s_lshl_b32 s58, s58, 10
    s_lshl_b32 s59, s59, 10
    s_lshl_b32 s60, s72, 7
    v_lshrrev_b32 v34, 3, v2
    v_lshlrev_b32 v34, 10, v34
    v_bfe_u32 v35, v2, 4, 2
    v_lshlrev_b32 v35, 1, v35
    v_and_b32 v36, 7, v2
    v_xor_b32 v35, v35, v36
    v_lshlrev_b32 v35, 4, v35
    v_add3_u32 v34, v34, v35, s60
    v_add_u32 v200, s58, v34
    v_add_u32 v201, 8192, v200
    v_add_u32 v202, s59, v34
    v_add_u32 v203, 8192, v202
    s_lshl_b32 s62, s18, 12
    s_add_u32 s69, s62, 77824
La_now2_2:
    s_lshl_b32 s54, s18, 11
    s_add_u32 s54, s54, 69632
    v_lshlrev_b32 v30, 5, v2
    v_add_u32 v30, s54, v30
    v_add_u32 v31, s54, v6
    v_lshrrev_b32 v32, 3, v2
    v_lshlrev_b32 v32, 15, v32
    v_and_b32 v33, 7, v2
    v_lshlrev_b32 v33, 4, v33
    s_lshl_b32 s55, s18, 19
    s_lshl_b32 s56, s19, 7
    s_add_u32 s55, s55, s56
    s_add_u32 s55, s55, 0
    v_add3_u32 v32, v32, v33, s55
    v_add_u32 v33, 0x40000, v32
    s_cmp_eq_u32 s18, 2
    s_cbranch_scc0 La_zs_3
    s_lshl_b32 s56, s2, 8
    s_add_u32 s56, s56, 2228224
    v_add_u32 v70, s56, v6
    v_mov_b32 v72, 0
    v_mov_b32 v73, 0
    v_mov_b32 v74, 0
    v_mov_b32 v75, 0
    s_mov_b64 s[56:57], exec
    s_mov_b64 exec, 0xffff
    global_store_dwordx4 v70, v[72:75], s[48:49] sc1
    s_mov_b64 exec, s[56:57]
La_zs_3:
    s_cmp_eq_u32 s18, 3
    s_cbranch_scc0 La_zb_4
    s_lshl_b32 s56, s2, 7
    s_add_u32 s56, s56, 2162688
    v_lshrrev_b32 v71, 3, v2
    v_mul_u32_u24 v71, 32768 - 128, v71
    v_add3_u32 v70, s56, v6, v71
    v_mov_b32 v72, 0
    v_mov_b32 v73, 0
    v_mov_b32 v74, 0
    v_mov_b32 v75, 0
    s_mov_b64 s[56:57], exec
    s_mov_b64 exec, 0xffff
    global_store_dwordx4 v70, v[72:75], s[48:49] sc1
    s_mov_b64 exec, s[56:57]
La_zb_4:
    v_mov_b32 v72, 0
    v_mov_b32 v73, 0
    v_mov_b32 v74, 0
    v_mov_b32 v75, 0
    v_lshrrev_b32 v70, 5, v2
    v_mul_u32_u24 v70, 4608, v70
    v_bfe_u32 v71, v2, 4, 1
    v_mul_u32_u24 v71, 2304, v71
    v_add_u32 v70, v70, v71
    v_and_b32 v71, 15, v2
    v_lshlrev_b32 v71, 4, v71
    v_add3_u32 v70, v70, v71, 0
    v_add_u32 v70, 114688, v70
    s_cmp_eq_u32 s18, 0
    s_cbranch_scc0 La_z2_5
    ds_write_b128 v70, v[72:75]
    s_branch La_z3_6
La_z2_5:
La_z3_6:
    s_lshl_b32 s54, s19, 5
    s_lshl_b32 s55, s18, 3
    s_add_u32 s54, s54, s55
    s_add_u32 s54, s54, 2097152
    v_bfe_u32 v70, v2, 3, 1
    v_lshl_add_u32 v70, v70, 2, s54
    v_cmp_le_u32 vcc, 56, v2
    s_mov_b32 s58, 0x3f803f80
    v_mov_b32 v64, 0
    v_mov_b32 v65, 0
    v_mov_b32 v66, 0
    v_mov_b32 v67, 0
    s_mov_b32 s56, 0x05040100
    s_mov_b32 s57, 0x07060302
    s_waitcnt vmcnt(9)
    v_perm_b32 v40, v17, v16, s56
    v_perm_b32 v44, v17, v16, s57
    v_perm_b32 v41, v19, v18, s56
    v_perm_b32 v45, v19, v18, s57
    v_perm_b32 v42, v21, v20, s56
    v_perm_b32 v46, v21, v20, s57
    v_perm_b32 v43, v23, v22, s56
    v_perm_b32 v47, v23, v22, s57
    ds_write_b128 v30, v[40:43]
    ds_write_b128 v30, v[44:47] offset:16
    ds_read_b128 v[48:51], v31
    ds_read_b128 v[52:55], v31 offset:1024
    s_waitcnt vmcnt(7)
    v_dot2c_f32_bf16 v64, s58, v8
    v_dot2c_f32_bf16 v65, v8, v8
    v_dot2c_f32_bf16 v66, s58, v12
    v_dot2c_f32_bf16 v67, v12, v12
    v_dot2c_f32_bf16 v64, s58, v9
    v_dot2c_f32_bf16 v65, v9, v9
    v_dot2c_f32_bf16 v66, s58, v13
    v_dot2c_f32_bf16 v67, v13, v13
    v_dot2c_f32_bf16 v64, s58, v10
    v_dot2c_f32_bf16 v65, v10, v10
    v_dot2c_f32_bf16 v66, s58, v14
    v_dot2c_f32_bf16 v67, v14, v14
    v_dot2c_f32_bf16 v64, s58, v11
    v_dot2c_f32_bf16 v65, v11, v11
    v_dot2c_f32_bf16 v66, s58, v15
    v_dot2c_f32_bf16 v67, v15, v15
    s_waitcnt lgkmcnt(0)
    global_store_dwordx4 v32, v[48:51], s[48:49] sc1
    global_store_dwordx4 v33, v[52:55], s[48:49] sc1
    v_add_f32_dpp v64, v64, v64 row_ror:8 row_mask:0xf bank_mask:0xf
    v_add_f32_dpp v65, v65, v65 row_ror:8 row_mask:0xf bank_mask:0xf
    v_add_f32_dpp v66, v66, v66 row_ror:8 row_mask:0xf bank_mask:0xf
    v_add_f32_dpp v67, v67, v67 row_ror:8 row_mask:0xf bank_mask:0xf
    v_add_f32_dpp v64, v64, v64 row_ror:4 row_mask:0xf bank_mask:0xf
    v_add_f32_dpp v65, v65, v65 row_ror:4 row_mask:0xf bank_mask:0xf
    v_add_f32_dpp v66, v66, v66 row_ror:4 row_mask:0xf bank_mask:0xf
    v_add_f32_dpp v67, v67, v67 row_ror:4 row_mask:0xf bank_mask:0xf
    v_add_f32_dpp v64, v64, v64 row_ror:2 row_mask:0xf bank_mask:0xf
    v_add_f32_dpp v65, v65, v65 row_ror:2 row_mask:0xf bank_mask:0xf
    v_add_f32_dpp v66, v66, v66 row_ror:2 row_mask:0xf bank_mask:0xf
    v_add_f32_dpp v67, v67, v67 row_ror:2 row_mask:0xf bank_mask:0xf
    v_add_f32_dpp v64, v64, v64 row_ror:1 row_mask:0xf bank_mask:0xf
    v_add_f32_dpp v65, v65, v65 row_ror:1 row_mask:0xf bank_mask:0xf
    v_add_f32_dpp v66, v66, v66 row_ror:1 row_mask:0xf bank_mask:0xf
    v_add_f32_dpp v67, v67, v67 row_ror:1 row_mask:0xf bank_mask:0xf
    v_add_f32_dpp v64, v64, v64 row_bcast:15 row_mask:0xa bank_mask:0xf
    v_add_f32_dpp v65, v65, v65 row_bcast:15 row_mask:0xa bank_mask:0xf
    v_add_f32_dpp v66, v66, v66 row_bcast:15 row_mask:0xa bank_mask:0xf
    v_add_f32_dpp v67, v67, v67 row_bcast:15 row_mask:0xa bank_mask:0xf
    v_add_f32_dpp v64, v64, v64 row_bcast:31 row_mask:0xc bank_mask:0xf
    v_add_f32_dpp v65, v65, v65 row_bcast:31 row_mask:0xc bank_mask:0xf
    v_add_f32_dpp v66, v66, v66 row_bcast:31 row_mask:0xc bank_mask:0xf
    v_add_f32_dpp v67, v67, v67 row_bcast:31 row_mask:0xc bank_mask:0xf
    v_cndmask_b32 v64, v64, v66, vcc
    v_cndmask_b32 v65, v65, v67, vcc
    v_mul_f32 v64, 0x3b000000, v64
    v_mul_f32 v65, 0x3b000000, v65
    v_fma_f32 v65, -v64, v64, v65
    v_max_f32 v65, 0, v65
    v_cvt_pk_bf16_f32 v65, v65, v65
    v_lshlrev_b32 v65, 16, v65
    v_add_f32 v65, 0x3727c5ac, v65
    v_cvt_pk_bf16_f32 v65, v65, v65
    v_lshlrev_b32 v65, 16, v65
    v_sqrt_f32 v65, v65
    s_nop 0
    v_cvt_pk_bf16_f32 v68, v64, v65
    s_mov_b32 exec_lo, 0
    s_mov_b32 exec_hi, 0x80800000
    global_store_dword v70, v68, s[48:49] sc1
    s_mov_b64 exec, -1
    s_waitcnt vmcnt(5)
    s_mul_i32 s63, s18, 17408
    v_lshlrev_b32 v5, 2, v2
    v_add_u32 v5, s63, v5
    v_and_b32 v7, 31, v2
    v_lshrrev_b32 v29, 5, v2
    v_mul_u32_u24 v8, 272, v7
    v_lshlrev_b32 v9, 4, v29
    v_add3_u32 v8, v8, v9, s63
    v_lshlrev_b32 v24, 16, v24
    v_lshlrev_b32 v25, 16, v25
    v_mul_f32 v24, 0x3fb8aa3b, v24
    v_mul_f32 v25, 0x3fb8aa3b, v25
    v_exp_f32 v24, v24
    v_exp_f32 v25, v25
    v_lshlrev_b32 v26, 16, v26
    v_lshlrev_b32 v27, 16, v27
    v_lshlrev_b32 v28, 16, v28
    v_cvt_pk_bf16_f32 v24, v24, v24
    v_cvt_pk_bf16_f32 v25, v25, v25
    v_lshlrev_b32 v24, 16, v24
    v_lshlrev_b32 v25, 16, v25
    v_mul_f32 v25, v25, v24
    v_mul_f32 v25, 0xbfb8aa3b, v25
    v_mul_f32 v26, v26, v24
    v_mul_f32 v26, 0x3e22f983, v26
    v_add_f32 v24, v24, v24
    v_mul_f32 v30, v27, v24
    v_mul_f32 v31, v28, v24
    v_mul_f32 v10, 0x41000000, v25
    v_mul_f32 v11, 0x41000000, v26
    v_exp_f32 v10, v10
    v_fract_f32 v11, v11
    v_cos_f32 v50, v11
    v_sin_f32 v51, v11
    s_nop 0
    v_mul_f32 v50, v50, v10
    v_mul_f32 v51, v51, v10
    v_exp_f32 v10, v25
    v_fract_f32 v11, v26
    v_cos_f32 v48, v11
    v_sin_f32 v49, v11
    s_nop 0
    v_mul_f32 v48, v48, v10
    v_mul_f32 v49, v49, v10
    v_mul_f32 v10, 0x43800000, v25
    v_mul_f32 v11, 0x43800000, v26
    v_exp_f32 v10, v10
    v_fract_f32 v11, v11
    v_cos_f32 v52, v11
    v_sin_f32 v53, v11
    s_nop 0
    v_mul_f32 v52, v52, v10
    v_mul_f32 v53, v53, v10
    v_mov_b32 v18, 0x3f80
    v_cvt_pk_bf16_f32 v10, v30, -v31
    ds_write_b32 v5, v18 offset:0
    ds_write_b32 v5, v10 offset:8704
    v_cvt_pk_bf16_f32 v11, v50, v51
    v_pk_mul_f32 v[32:33], v[30:31], v[48:49] op_sel:[0,0] op_sel_hi:[1,0]
    ds_write_b32 v5, v11 offset:272
    v_pk_fma_f32 v[32:33], v[30:31], v[48:49], v[32:33] op_sel:[1,1,0] op_sel_hi:[0,1,1] neg_lo:[1,0,0]
    v_cvt_pk_bf16_f32 v12, v32, -v33
    ds_write_b32 v5, v12 offset:8976
    v_pk_mul_f32 v[66:67], v[50:51], v[50:51] op_sel:[0,0] op_sel_hi:[1,0]
    v_pk_mul_f32 v[34:35], v[32:33], v[48:49] op_sel:[0,0] op_sel_hi:[1,0]
    v_pk_fma_f32 v[66:67], v[50:51], v[50:51], v[66:67] op_sel:[1,1,0] op_sel_hi:[0,1,1] neg_lo:[1,0,0]
    v_pk_fma_f32 v[34:35], v[32:33], v[48:49], v[34:35] op_sel:[1,1,0] op_sel_hi:[0,1,1] neg_lo:[1,0,0]
    v_cvt_pk_bf16_f32 v13, v66, v67
    v_cvt_pk_bf16_f32 v14, v34, -v35
    ds_write_b32 v5, v13 offset:544
    ds_write_b32 v5, v14 offset:9248
    v_pk_mul_f32 v[68:69], v[66:67], v[50:51] op_sel:[0,0] op_sel_hi:[1,0]
    v_pk_mul_f32 v[36:37], v[34:35], v[48:49] op_sel:[0,0] op_sel_hi:[1,0]
    v_pk_fma_f32 v[68:69], v[66:67], v[50:51], v[68:69] op_sel:[1,1,0] op_sel_hi:[0,1,1] neg_lo:[1,0,0]
    v_pk_fma_f32 v[36:37], v[34:35], v[48:49], v[36:37] op_sel:[1,1,0] op_sel_hi:[0,1,1] neg_lo:[1,0,0]
    v_cvt_pk_bf16_f32 v15, v68, v69
    v_cvt_pk_bf16_f32 v16, v36, -v37
    ds_write_b32 v5, v15 offset:816
    ds_write_b32 v5, v16 offset:9520
    v_pk_mul_f32 v[66:67], v[68:69], v[50:51] op_sel:[0,0] op_sel_hi:[1,0]
    v_pk_mul_f32 v[38:39], v[36:37], v[48:49] op_sel:[0,0] op_sel_hi:[1,0]
    v_pk_fma_f32 v[66:67], v[68:69], v[50:51], v[66:67] op_sel:[1,1,0] op_sel_hi:[0,1,1] neg_lo:[1,0,0]
    v_pk_fma_f32 v[38:39], v[36:37], v[48:49], v[38:39] op_sel:[1,1,0] op_sel_hi:[0,1,1] neg_lo:[1,0,0]
    v_cvt_pk_bf16_f32 v17, v66, v67
    v_cvt_pk_bf16_f32 v10, v38, -v39
    ds_write_b32 v5, v17 offset:1088
    ds_write_b32 v5, v10 offset:9792
    v_pk_mul_f32 v[68:69], v[66:67], v[50:51] op_sel:[0,0] op_sel_hi:[1,0]
    v_pk_mul_f32 v[40:41], v[38:39], v[48:49] op_sel:[0,0] op_sel_hi:[1,0]
    v_pk_fma_f32 v[68:69], v[66:67], v[50:51], v[68:69] op_sel:[1,1,0] op_sel_hi:[0,1,1] neg_lo:[1,0,0]
    v_pk_fma_f32 v[40:41], v[38:39], v[48:49], v[40:41] op_sel:[1,1,0] op_sel_hi:[0,1,1] neg_lo:[1,0,0]
    v_cvt_pk_bf16_f32 v11, v68, v69
    v_cvt_pk_bf16_f32 v12, v40, -v41
    ds_write_b32 v5, v11 offset:1360
    ds_write_b32 v5, v12 offset:10064
    v_pk_mul_f32 v[66:67], v[68:69], v[50:51] op_sel:[0,0] op_sel_hi:[1,0]
    v_pk_mul_f32 v[42:43], v[40:41], v[48:49] op_sel:[0,0] op_sel_hi:[1,0]
    v_pk_fma_f32 v[66:67], v[68:69], v[50:51], v[66:67] op_sel:[1,1,0] op_sel_hi:[0,1,1] neg_lo:[1,0,0]
    v_pk_fma_f32 v[42:43], v[40:41], v[48:49], v[42:43] op_sel:[1,1,0] op_sel_hi:[0,1,1] neg_lo:[1,0,0]
    v_cvt_pk_bf16_f32 v13, v66, v67
    v_cvt_pk_bf16_f32 v14, v42, -v43
    ds_write_b32 v5, v13 offset:1632
    ds_write_b32 v5, v14 offset:10336
    v_pk_mul_f32 v[68:69], v[66:67], v[50:51] op_sel:[0,0] op_sel_hi:[1,0]
    v_pk_mul_f32 v[44:45], v[42:43], v[48:49] op_sel:[0,0] op_sel_hi:[1,0]
    v_pk_fma_f32 v[68:69], v[66:67], v[50:51], v[68:69] op_sel:[1,1,0] op_sel_hi:[0,1,1] neg_lo:[1,0,0]
    v_pk_fma_f32 v[44:45], v[42:43], v[48:49], v[44:45] op_sel:[1,1,0] op_sel_hi:[0,1,1] neg_lo:[1,0,0]
    v_cvt_pk_bf16_f32 v15, v68, v69
    v_cvt_pk_bf16_f32 v16, v44, -v45
    ds_write_b32 v5, v15 offset:1904
    ds_write_b32 v5, v16 offset:10608
    v_pk_mul_f32 v[66:67], v[68:69], v[50:51] op_sel:[0,0] op_sel_hi:[1,0]
    v_pk_mul_f32 v[46:47], v[44:45], v[48:49] op_sel:[0,0] op_sel_hi:[1,0]
    v_pk_fma_f32 v[66:67], v[68:69], v[50:51], v[66:67] op_sel:[1,1,0] op_sel_hi:[0,1,1] neg_lo:[1,0,0]
    v_pk_fma_f32 v[46:47], v[44:45], v[48:49], v[46:47] op_sel:[1,1,0] op_sel_hi:[0,1,1] neg_lo:[1,0,0]
    v_cvt_pk_bf16_f32 v17, v66, v67
    ds_write_b32 v5, v17 offset:2176
    v_pk_mul_f32 v[68:69], v[66:67], v[50:51] op_sel:[0,0] op_sel_hi:[1,0]
    v_pk_mul_f32 v[54:55], v[52:53], v[52:53] op_sel:[0,0] op_sel_hi:[1,0]
    v_pk_fma_f32 v[68:69], v[66:67], v[50:51], v[68:69] op_sel:[1,1,0] op_sel_hi:[0,1,1] neg_lo:[1,0,0]
    v_pk_fma_f32 v[54:55], v[52:53], v[52:53], v[54:55] op_sel:[1,1,0] op_sel_hi:[0,1,1] neg_lo:[1,0,0]
    v_cvt_pk_bf16_f32 v10, v68, v69
    ds_write_b32 v5, v10 offset:2448
    v_pk_mul_f32 v[66:67], v[68:69], v[50:51] op_sel:[0,0] op_sel_hi:[1,0]
    v_pk_mul_f32 v[56:57], v[54:55], v[52:53] op_sel:[0,0] op_sel_hi:[1,0]
    v_pk_fma_f32 v[66:67], v[68:69], v[50:51], v[66:67] op_sel:[1,1,0] op_sel_hi:[0,1,1] neg_lo:[1,0,0]
    v_pk_fma_f32 v[56:57], v[54:55], v[52:53], v[56:57] op_sel:[1,1,0] op_sel_hi:[0,1,1] neg_lo:[1,0,0]
    v_cvt_pk_bf16_f32 v11, v66, v67
    ds_write_b32 v5, v11 offset:2720
    v_pk_mul_f32 v[68:69], v[66:67], v[50:51] op_sel:[0,0] op_sel_hi:[1,0]
    v_pk_mul_f32 v[58:59], v[54:55], v[54:55] op_sel:[0,0] op_sel_hi:[1,0]
    v_pk_fma_f32 v[68:69], v[66:67], v[50:51], v[68:69] op_sel:[1,1,0] op_sel_hi:[0,1,1] neg_lo:[1,0,0]
    v_pk_fma_f32 v[58:59], v[54:55], v[54:55], v[58:59] op_sel:[1,1,0] op_sel_hi:[0,1,1] neg_lo:[1,0,0]
    v_cvt_pk_bf16_f32 v12, v68, v69
    ds_write_b32 v5, v12 offset:2992
    s_and_b32 s56, s2, 3
    s_lshl_b32 s56, s56, 6
    v_mov_b32 v21, s56
    v_mov_b32 v22, 1
    s_waitcnt vmcnt(0)
    s_barrier
    s_cmp_eq_u32 s18, 0
    s_cbranch_scc0 Larr_7
    s_mov_b64 exec, 1
    global_atomic_add v21, v22, s[46:47] sc1
    s_mov_b64 exec, -1
Larr_7:
    s_cmp_eq_u32 s70, 1
    s_cbranch_scc0 Lw2d_8
    s_add_u32 m0, s69, 0
    s_nop 0
    global_load_lds_dwordx4 v200, s[40:41] nt
    s_add_u32 m0, s69, 1024
    s_nop 0
    global_load_lds_dwordx4 v201, s[40:41] nt
    s_add_u32 m0, s69, 2048
    s_nop 0
    global_load_lds_dwordx4 v202, s[40:41] nt
    s_add_u32 m0, s69, 3072
    s_nop 0
    global_load_lds_dwordx4 v203, s[40:41] nt
Lw2d_8:
    s_mul_i32 s53, s18, 3584
    s_mul_i32 s54, s17, 64
    s_add_u32 s54, s54, s53
    s_lshl_b32 s54, s54, 7
    v_min_u32 v19, 63, v2
    v_lshlrev_b32 v19, 7, v19
    v_add_u32 v19, s54, v19
    s_mul_i32 s54, s17, 48
    s_add_u32 s54, s54, s53
    s_add_u32 s54, s54, 2048
    s_lshl_b32 s54, s54, 7
    v_min_u32 v167, 47, v2
    v_lshlrev_b32 v167, 7, v167
    v_add_u32 v167, s54, v167
    s_mov_b32 exec_lo, 0xffffffff
    s_mov_b32 exec_hi, 0xffffffff
    global_load_dword v254, v19, s[36:37]
    s_mov_b64 exec, -1
    v_pk_mul_f32 v[66:67], v[68:69], v[50:51] op_sel:[0,0] op_sel_hi:[1,0]
    v_pk_mul_f32 v[60:61], v[58:59], v[52:53] op_sel:[0,0] op_sel_hi:[1,0]
    v_pk_fma_f32 v[66:67], v[68:69], v[50:51], v[66:67] op_sel:[1,1,0] op_sel_hi:[0,1,1] neg_lo:[1,0,0]
    v_pk_fma_f32 v[60:61], v[58:59], v[52:53], v[60:61] op_sel:[1,1,0] op_sel_hi:[0,1,1] neg_lo:[1,0,0]
    v_cvt_pk_bf16_f32 v13, v66, v67
    ds_write_b32 v5, v13 offset:3264
    v_pk_mul_f32 v[68:69], v[66:67], v[50:51] op_sel:[0,0] op_sel_hi:[1,0]
    v_pk_mul_f32 v[62:63], v[58:59], v[54:55] op_sel:[0,0] op_sel_hi:[1,0]
    v_pk_fma_f32 v[68:69], v[66:67], v[50:51], v[68:69] op_sel:[1,1,0] op_sel_hi:[0,1,1] neg_lo:[1,0,0]
    v_pk_fma_f32 v[62:63], v[58:59], v[54:55], v[62:63] op_sel:[1,1,0] op_sel_hi:[0,1,1] neg_lo:[1,0,0]
    v_cvt_pk_bf16_f32 v14, v68, v69
    ds_write_b32 v5, v14 offset:3536
    v_pk_mul_f32 v[66:67], v[68:69], v[50:51] op_sel:[0,0] op_sel_hi:[1,0]
    v_pk_mul_f32 v[64:65], v[58:59], v[56:57] op_sel:[0,0] op_sel_hi:[1,0]
    v_pk_fma_f32 v[66:67], v[68:69], v[50:51], v[66:67] op_sel:[1,1,0] op_sel_hi:[0,1,1] neg_lo:[1,0,0]
    v_pk_fma_f32 v[64:65], v[58:59], v[56:57], v[64:65] op_sel:[1,1,0] op_sel_hi:[0,1,1] neg_lo:[1,0,0]
    v_cvt_pk_bf16_f32 v15, v66, v67
    ds_write_b32 v5, v15 offset:3808
    v_pk_mul_f32 v[68:69], v[66:67], v[50:51] op_sel:[0,0] op_sel_hi:[1,0]
    v_pk_mul_f32 v[70:71], v[52:53], v[30:31] op_sel:[0,0] op_sel_hi:[1,0]
    v_pk_fma_f32 v[68:69], v[66:67], v[50:51], v[68:69] op_sel:[1,1,0] op_sel_hi:[0,1,1] neg_lo:[1,0,0]
    v_pk_fma_f32 v[70:71], v[52:53], v[30:31], v[70:71] op_sel:[1,1,0] op_sel_hi:[0,1,1] neg_lo:[1,0,0]
    v_cvt_pk_bf16_f32 v16, v68, v69
    v_cvt_pk_bf16_f32 v17, v70, -v71
    ds_write_b32 v5, v16 offset:4080
    ds_write_b32 v5, v17 offset:10880
    v_pk_mul_f32 v[66:67], v[68:69], v[50:51] op_sel:[0,0] op_sel_hi:[1,0]
    v_pk_mul_f32 v[72:73], v[52:53], v[34:35] op_sel:[0,0] op_sel_hi:[1,0]
    v_pk_fma_f32 v[66:67], v[68:69], v[50:51], v[66:67] op_sel:[1,1,0] op_sel_hi:[0,1,1] neg_lo:[1,0,0]
    v_pk_fma_f32 v[72:73], v[52:53], v[34:35], v[72:73] op_sel:[1,1,0] op_sel_hi:[0,1,1] neg_lo:[1,0,0]
    v_cvt_pk_bf16_f32 v10, v66, v67
    v_cvt_pk_bf16_f32 v11, v72, -v73
    ds_write_b32 v5, v10 offset:4352
    ds_write_b32 v5, v11 offset:11152
    v_pk_mul_f32 v[68:69], v[66:67], v[50:51] op_sel:[0,0] op_sel_hi:[1,0]
    v_pk_mul_f32 v[74:75], v[52:53], v[38:39] op_sel:[0,0] op_sel_hi:[1,0]
    v_pk_fma_f32 v[68:69], v[66:67], v[50:51], v[68:69] op_sel:[1,1,0] op_sel_hi:[0,1,1] neg_lo:[1,0,0]
    v_pk_fma_f32 v[74:75], v[52:53], v[38:39], v[74:75] op_sel:[1,1,0] op_sel_hi:[0,1,1] neg_lo:[1,0,0]
    v_cvt_pk_bf16_f32 v12, v68, v69
    v_cvt_pk_bf16_f32 v13, v74, -v75
    ds_write_b32 v5, v12 offset:4624
    ds_write_b32 v5, v13 offset:11424
    ds_write_b32 v5, v13 offset:11968
    v_pk_mul_f32 v[66:67], v[68:69], v[50:51] op_sel:[0,0] op_sel_hi:[1,0]
    v_pk_mul_f32 v[76:77], v[52:53], v[42:43] op_sel:[0,0] op_sel_hi:[1,0]
    v_pk_fma_f32 v[66:67], v[68:69], v[50:51], v[66:67] op_sel:[1,1,0] op_sel_hi:[0,1,1] neg_lo:[1,0,0]
    v_pk_fma_f32 v[76:77], v[52:53], v[42:43], v[76:77] op_sel:[1,1,0] op_sel_hi:[0,1,1] neg_lo:[1,0,0]
    v_cvt_pk_bf16_f32 v14, v66, v67
    v_cvt_pk_bf16_f32 v15, v76, -v77
    ds_write_b32 v5, v14 offset:4896
    ds_write_b32 v5, v15 offset:12240
    v_pk_mul_f32 v[68:69], v[66:67], v[50:51] op_sel:[0,0] op_sel_hi:[1,0]
    v_pk_mul_f32 v[70:71], v[52:53], v[46:47] op_sel:[0,0] op_sel_hi:[1,0]
    v_pk_fma_f32 v[68:69], v[66:67], v[50:51], v[68:69] op_sel:[1,1,0] op_sel_hi:[0,1,1] neg_lo:[1,0,0]
    v_pk_fma_f32 v[70:71], v[52:53], v[46:47], v[70:71] op_sel:[1,1,0] op_sel_hi:[0,1,1] neg_lo:[1,0,0]
    v_cvt_pk_bf16_f32 v16, v68, v69
    v_cvt_pk_bf16_f32 v17, v70, -v71
    ds_write_b32 v5, v16 offset:5168
    ds_write_b32 v5, v17 offset:12512
    v_pk_mul_f32 v[66:67], v[68:69], v[50:51] op_sel:[0,0] op_sel_hi:[1,0]
    v_pk_mul_f32 v[72:73], v[54:55], v[30:31] op_sel:[0,0] op_sel_hi:[1,0]
    v_pk_fma_f32 v[66:67], v[68:69], v[50:51], v[66:67] op_sel:[1,1,0] op_sel_hi:[0,1,1] neg_lo:[1,0,0]
    v_pk_fma_f32 v[72:73], v[54:55], v[30:31], v[72:73] op_sel:[1,1,0] op_sel_hi:[0,1,1] neg_lo:[1,0,0]
    v_cvt_pk_bf16_f32 v10, v66, v67
    v_cvt_pk_bf16_f32 v11, v72, -v73
    ds_write_b32 v5, v10 offset:5440
    ds_write_b32 v5, v11 offset:13056
    v_pk_mul_f32 v[68:69], v[66:67], v[50:51] op_sel:[0,0] op_sel_hi:[1,0]
    v_pk_mul_f32 v[74:75], v[54:55], v[38:39] op_sel:[0,0] op_sel_hi:[1,0]
    v_pk_fma_f32 v[68:69], v[66:67], v[50:51], v[68:69] op_sel:[1,1,0] op_sel_hi:[0,1,1] neg_lo:[1,0,0]
    v_pk_fma_f32 v[74:75], v[54:55], v[38:39], v[74:75] op_sel:[1,1,0] op_sel_hi:[0,1,1] neg_lo:[1,0,0]
    v_cvt_pk_bf16_f32 v12, v68, v69
    v_cvt_pk_bf16_f32 v13, v74, -v75
    ds_write_b32 v5, v12 offset:5712
    ds_write_b32 v5, v13 offset:13328
    ds_write_b32 v5, v13 offset:14144
    v_pk_mul_f32 v[66:67], v[68:69], v[50:51] op_sel:[0,0] op_sel_hi:[1,0]
    v_pk_mul_f32 v[76:77], v[54:55], v[46:47] op_sel:[0,0] op_sel_hi:[1,0]
    v_pk_fma_f32 v[66:67], v[68:69], v[50:51], v[66:67] op_sel:[1,1,0] op_sel_hi:[0,1,1] neg_lo:[1,0,0]
    v_pk_fma_f32 v[76:77], v[54:55], v[46:47], v[76:77] op_sel:[1,1,0] op_sel_hi:[0,1,1] neg_lo:[1,0,0]
    v_cvt_pk_bf16_f32 v14, v66, v67
    v_cvt_pk_bf16_f32 v15, v76, -v77
    ds_write_b32 v5, v14 offset:5984
    ds_write_b32 v5, v15 offset:14416
    v_pk_mul_f32 v[68:69], v[66:67], v[50:51] op_sel:[0,0] op_sel_hi:[1,0]
    v_pk_mul_f32 v[70:71], v[56:57], v[30:31] op_sel:[0,0] op_sel_hi:[1,0]
    v_pk_fma_f32 v[68:69], v[66:67], v[50:51], v[68:69] op_sel:[1,1,0] op_sel_hi:[0,1,1] neg_lo:[1,0,0]
    v_pk_fma_f32 v[70:71], v[56:57], v[30:31], v[70:71] op_sel:[1,1,0] op_sel_hi:[0,1,1] neg_lo:[1,0,0]
    v_cvt_pk_bf16_f32 v16, v68, v69
    v_cvt_pk_bf16_f32 v17, v70, -v71
    ds_write_b32 v5, v16 offset:6256
    ds_write_b32 v5, v17 offset:13600
    v_pk_mul_f32 v[66:67], v[68:69], v[50:51] op_sel:[0,0] op_sel_hi:[1,0]
    v_pk_mul_f32 v[72:73], v[56:57], v[38:39] op_sel:[0,0] op_sel_hi:[1,0]
    v_pk_fma_f32 v[66:67], v[68:69], v[50:51], v[66:67] op_sel:[1,1,0] op_sel_hi:[0,1,1] neg_lo:[1,0,0]
    v_pk_fma_f32 v[72:73], v[56:57], v[38:39], v[72:73] op_sel:[1,1,0] op_sel_hi:[0,1,1] neg_lo:[1,0,0]
    v_cvt_pk_bf16_f32 v10, v66, v67
    v_cvt_pk_bf16_f32 v11, v72, -v73
    ds_write_b32 v5, v10 offset:6528
    ds_write_b32 v5, v11 offset:13872
    ds_write_b32 v5, v11 offset:14688
    v_pk_mul_f32 v[68:69], v[66:67], v[50:51] op_sel:[0,0] op_sel_hi:[1,0]
    v_pk_mul_f32 v[74:75], v[56:57], v[46:47] op_sel:[0,0] op_sel_hi:[1,0]
    v_pk_fma_f32 v[68:69], v[66:67], v[50:51], v[68:69] op_sel:[1,1,0] op_sel_hi:[0,1,1] neg_lo:[1,0,0]
    v_pk_fma_f32 v[74:75], v[56:57], v[46:47], v[74:75] op_sel:[1,1,0] op_sel_hi:[0,1,1] neg_lo:[1,0,0]
    v_cvt_pk_bf16_f32 v12, v68, v69
    v_cvt_pk_bf16_f32 v13, v74, -v75
    ds_write_b32 v5, v12 offset:6800
    ds_write_b32 v5, v13 offset:14960
    v_pk_mul_f32 v[66:67], v[68:69], v[50:51] op_sel:[0,0] op_sel_hi:[1,0]
    v_pk_mul_f32 v[76:77], v[58:59], v[30:31] op_sel:[0,0] op_sel_hi:[1,0]
    v_pk_fma_f32 v[66:67], v[68:69], v[50:51], v[66:67] op_sel:[1,1,0] op_sel_hi:[0,1,1] neg_lo:[1,0,0]
    v_pk_fma_f32 v[76:77], v[58:59], v[30:31], v[76:77] op_sel:[1,1,0] op_sel_hi:[0,1,1] neg_lo:[1,0,0]
    v_cvt_pk_bf16_f32 v14, v66, v67
    v_cvt_pk_bf16_f32 v15, v76, -v77
    ds_write_b32 v5, v14 offset:7072
    ds_write_b32 v5, v15 offset:15232
    v_pk_mul_f32 v[68:69], v[66:67], v[50:51] op_sel:[0,0] op_sel_hi:[1,0]
    v_pk_mul_f32 v[70:71], v[58:59], v[46:47] op_sel:[0,0] op_sel_hi:[1,0]
    v_pk_fma_f32 v[68:69], v[66:67], v[50:51], v[68:69] op_sel:[1,1,0] op_sel_hi:[0,1,1] neg_lo:[1,0,0]
    v_pk_fma_f32 v[70:71], v[58:59], v[46:47], v[70:71] op_sel:[1,1,0] op_sel_hi:[0,1,1] neg_lo:[1,0,0]
    v_cvt_pk_bf16_f32 v16, v68, v69
    v_cvt_pk_bf16_f32 v17, v70, -v71
    ds_write_b32 v5, v16 offset:7344
    ds_write_b32 v5, v17 offset:15504
    v_pk_mul_f32 v[66:67], v[68:69], v[50:51] op_sel:[0,0] op_sel_hi:[1,0]
    v_pk_mul_f32 v[72:73], v[60:61], v[30:31] op_sel:[0,0] op_sel_hi:[1,0]
    v_pk_fma_f32 v[66:67], v[68:69], v[50:51], v[66:67] op_sel:[1,1,0] op_sel_hi:[0,1,1] neg_lo:[1,0,0]
    v_pk_fma_f32 v[72:73], v[60:61], v[30:31], v[72:73] op_sel:[1,1,0] op_sel_hi:[0,1,1] neg_lo:[1,0,0]
    v_cvt_pk_bf16_f32 v10, v66, v67
    v_cvt_pk_bf16_f32 v11, v72, -v73
    ds_write_b32 v5, v10 offset:7616
    ds_write_b32 v5, v11 offset:15776
    v_pk_mul_f32 v[68:69], v[66:67], v[50:51] op_sel:[0,0] op_sel_hi:[1,0]
    v_pk_mul_f32 v[74:75], v[60:61], v[46:47] op_sel:[0,0] op_sel_hi:[1,0]
    v_pk_fma_f32 v[68:69], v[66:67], v[50:51], v[68:69] op_sel:[1,1,0] op_sel_hi:[0,1,1] neg_lo:[1,0,0]
    v_pk_fma_f32 v[74:75], v[60:61], v[46:47], v[74:75] op_sel:[1,1,0] op_sel_hi:[0,1,1] neg_lo:[1,0,0]
    v_cvt_pk_bf16_f32 v12, v68, v69
    v_cvt_pk_bf16_f32 v13, v74, -v75
    ds_write_b32 v5, v12 offset:7888
    ds_write_b32 v5, v13 offset:16048
    v_pk_mul_f32 v[66:67], v[68:69], v[50:51] op_sel:[0,0] op_sel_hi:[1,0]
    v_pk_mul_f32 v[76:77], v[62:63], v[30:31] op_sel:[0,0] op_sel_hi:[1,0]
    v_pk_fma_f32 v[66:67], v[68:69], v[50:51], v[66:67] op_sel:[1,1,0] op_sel_hi:[0,1,1] neg_lo:[1,0,0]
    v_pk_fma_f32 v[76:77], v[62:63], v[30:31], v[76:77] op_sel:[1,1,0] op_sel_hi:[0,1,1] neg_lo:[1,0,0]
    v_cvt_pk_bf16_f32 v14, v66, v67
    v_cvt_pk_bf16_f32 v15, v76, -v77
    ds_write_b32 v5, v14 offset:8160
    ds_write_b32 v5, v15 offset:16320
    v_pk_mul_f32 v[68:69], v[66:67], v[50:51] op_sel:[0,0] op_sel_hi:[1,0]
    v_pk_mul_f32 v[70:71], v[62:63], v[46:47] op_sel:[0,0] op_sel_hi:[1,0]
    v_pk_fma_f32 v[68:69], v[66:67], v[50:51], v[68:69] op_sel:[1,1,0] op_sel_hi:[0,1,1] neg_lo:[1,0,0]
    v_pk_fma_f32 v[70:71], v[62:63], v[46:47], v[70:71] op_sel:[1,1,0] op_sel_hi:[0,1,1] neg_lo:[1,0,0]
    v_cvt_pk_bf16_f32 v16, v68, v69
    v_cvt_pk_bf16_f32 v17, v70, -v71
    ds_write_b32 v5, v16 offset:8432
    ds_write_b32 v5, v17 offset:16592
    v_pk_mul_f32 v[72:73], v[64:65], v[30:31] op_sel:[0,0] op_sel_hi:[1,0]
    v_pk_fma_f32 v[72:73], v[64:65], v[30:31], v[72:73] op_sel:[1,1,0] op_sel_hi:[0,1,1] neg_lo:[1,0,0]
    v_cvt_pk_bf16_f32 v10, v72, -v73
    ds_write_b32 v5, v10 offset:16864
    v_pk_mul_f32 v[74:75], v[64:65], v[46:47] op_sel:[0,0] op_sel_hi:[1,0]
    v_pk_fma_f32 v[74:75], v[64:65], v[46:47], v[74:75] op_sel:[1,1,0] op_sel_hi:[0,1,1] neg_lo:[1,0,0]
    v_cvt_pk_bf16_f32 v11, v74, -v75
    ds_write_b32 v5, v11 offset:17136
    ds_read_b128 v[80:83], v8 offset:8704
    ds_read_b128 v[84:87], v8 offset:0
    ds_read_b128 v[88:91], v8 offset:8736
    ds_read_b128 v[92:95], v8 offset:32
    ds_read_b128 v[96:99], v8 offset:8768
    ds_read_b128 v[100:103], v8 offset:64
    ds_read_b128 v[104:107], v8 offset:8800
    ds_read_b128 v[108:111], v8 offset:96
    ds_read_b128 v[112:115], v8 offset:8832
    ds_read_b128 v[116:119], v8 offset:128
    ds_read_b128 v[120:123], v8 offset:8864
    ds_read_b128 v[124:127], v8 offset:160
    ds_read_b128 v[128:131], v8 offset:8896
    ds_read_b128 v[132:135], v8 offset:192
    ds_read_b128 v[136:139], v8 offset:8928
    ds_read_b128 v[140:143], v8 offset:224
    s_waitcnt lgkmcnt(14)
    v_mfma_f32_32x32x16_bf16 v[144:159], v[80:83], v[84:87], 0
    s_waitcnt lgkmcnt(12)
    v_mfma_f32_32x32x16_bf16 v[144:159], v[88:91], v[92:95], v[144:159]
    s_waitcnt lgkmcnt(10)
    v_mfma_f32_32x32x16_bf16 v[144:159], v[96:99], v[100:103], v[144:159]
    s_waitcnt lgkmcnt(8)
    v_mfma_f32_32x32x16_bf16 v[144:159], v[104:107], v[108:111], v[144:159]
    s_waitcnt lgkmcnt(6)
    v_mfma_f32_32x32x16_bf16 v[144:159], v[112:115], v[116:119], v[144:159]
    s_waitcnt lgkmcnt(4)
    v_mfma_f32_32x32x16_bf16 v[144:159], v[120:123], v[124:127], v[144:159]
    s_waitcnt lgkmcnt(2)
    v_mfma_f32_32x32x16_bf16 v[144:159], v[128:131], v[132:135], v[144:159]
    s_waitcnt lgkmcnt(0)
    v_mfma_f32_32x32x16_bf16 v[144:159], v[136:139], v[140:143], v[144:159]
    v_add_u32 v15, s63, v6
    s_xor_b32 s54, s18, 1
    s_mul_i32 s54, s54, 17408
    v_add_u32 v9, s54, v6
    s_lshr_b32 s55, s18, 1
    s_mul_i32 s55, s55, 34816
    s_add_u32 s55, s55, 4096
    v_lshlrev_b32 v12, 4, v7
    v_lshlrev_b32 v13, 3, v29
    v_add_u32 v13, v12, v13
    s_add_u32 s56, s55, 504
    v_sub_u32 v13, s56, v13
    s_and_b32 s57, s18, 1
    s_cmp_eq_u32 s57, 0
    s_cbranch_scc0 Lkg_mh1_9
    s_nop 7
    ds_write_b128 v15, v[152:155]
    ds_write_b128 v15, v[156:159] offset:1024
    s_waitcnt lgkmcnt(0)
    s_barrier
    ds_read_b128 v[80:83], v9
    ds_read_b128 v[84:87], v9 offset:1024
    v_mov_b32 v64, 0
    v_mov_b32 v65, 0
    v_mov_b32 v66, 0
    v_mov_b32 v67, 0
    v_mov_b32 v68, s55
    s_mov_b64 s[56:57], exec
    s_mov_b64 exec, 1
    ds_write_b128 v68, v[64:67] offset:4096
    s_mov_b64 exec, s[56:57]
    s_waitcnt lgkmcnt(1)
    v_add_f32 v144, v144, v80
    v_add_f32 v145, v145, v81
    v_add_f32 v146, v146, v82
    v_add_f32 v147, v147, v83
    v_add_f32 v148, v148, v84
    v_add_f32 v149, v149, v85
    v_add_f32 v150, v150, v86
    v_add_f32 v151, v151, v87
    v_cvt_pk_bf16_f32 v70, v147, v146
    v_cvt_pk_bf16_f32 v71, v145, v144
    v_cvt_pk_bf16_f32 v72, v150, v149
    v_cvt_pk_bf16_f32 v73, v148, v148
    ds_write_b64 v13, v[70:71] offset:3584
    ds_write_b64 v13, v[72:73] offset:3072
    s_branch Lkg_join_10
Lkg_mh1_9:
    s_nop 7
    ds_write_b128 v15, v[144:147]
    ds_write_b128 v15, v[148:151] offset:1024
    s_waitcnt lgkmcnt(0)
    s_barrier
    ds_read_b128 v[80:83], v9
    ds_read_b128 v[84:87], v9 offset:1024
    v_lshlrev_b32 v64, 10, v29
    v_add_u32 v64, v64, v12
    s_add_u32 s56, s55, 1520
    v_sub_u32 v64, s56, v64
    v_cmp_eq_u32 s[58:59], 1, v29
    v_and_b32 v65, 1, v7
    v_cmp_eq_u32 s[60:61], 1, v65
    s_waitcnt lgkmcnt(0)
    v_add_f32 v152, v152, v80
    v_add_f32 v153, v153, v81
    v_add_f32 v154, v154, v82
    v_add_f32 v155, v155, v83
    v_add_f32 v156, v156, v84
    v_add_f32 v157, v157, v85
    v_add_f32 v158, v158, v86
    v_add_f32 v159, v159, v87
    v_cndmask_b32 v66, v152, v153, s[58:59]
    v_cvt_pk_bf16_f32 v70, v153, v66
    v_cvt_pk_bf16_f32 v71, v152, v152
    ds_write_b64 v13, v[70:71] offset:2560
    v_cndmask_b32 v66, v154, v155, s[58:59]
    v_cvt_pk_bf16_f32 v72, v155, v66
    v_cvt_pk_bf16_f32 v73, v154, v154
    ds_write_b64 v13, v[72:73] offset:2048
    v_cndmask_b32 v66, v156, v157, s[60:61]
    v_cvt_pk_bf16_f32 v80, v157, v157
    v_cvt_pk_bf16_f32 v81, v157, v66
    v_cvt_pk_bf16_f32 v82, v156, v156
    v_cvt_pk_bf16_f32 v83, v156, v156
    ds_write_b128 v64, v[80:83] offset:512
    v_cndmask_b32 v66, v158, v159, s[60:61]
    v_cvt_pk_bf16_f32 v84, v159, v159
    v_cvt_pk_bf16_f32 v85, v159, v66
    v_cvt_pk_bf16_f32 v86, v158, v158
    v_cvt_pk_bf16_f32 v87, v158, v158
    ds_write_b128 v64, v[84:87] offset:0
Lkg_join_10:
    s_waitcnt lgkmcnt(0)
    s_barrier
    v_lshrrev_b32 v3, 7, v0
    v_and_b32 v4, 127, v0
    v_lshlrev_b32 v4, 4, v4
    v_mul_u32_u24 v5, 34816, v3
    v_add_u32 v5, v5, v4
    v_add_u32 v5, 4096, v5
    v_mul_u32_u24 v7, 16640, v3
    v_add_u32 v7, v7, v4
    v_add_u32 v7, 123904, v7
    ds_read_b128 v[16:19], v5 offset:0
    ds_read_b64 v[20:21], v5 offset:16
    ds_read_b128 v[40:43], v5 offset:2048
    ds_read_b64 v[44:45], v5 offset:2064
    s_waitcnt lgkmcnt(2)
    v_alignbit_b32 v24, v17, v16, 16
    v_alignbit_b32 v25, v18, v17, 16
    v_alignbit_b32 v26, v19, v18, 16
    v_alignbit_b32 v27, v20, v19, 16
    v_mov_b32 v28, v17
    v_mov_b32 v29, v18
    v_mov_b32 v30, v19
    v_mov_b32 v31, v20
    v_alignbit_b32 v32, v18, v17, 16
    v_alignbit_b32 v33, v19, v18, 16
    v_alignbit_b32 v34, v20, v19, 16
    v_alignbit_b32 v35, v21, v20, 16
    ds_write_b128 v7, v[16:19] offset:0
    ds_write_b128 v7, v[24:27] offset:4160
    ds_write_b128 v7, v[28:31] offset:8320
    ds_write_b128 v7, v[32:35] offset:12480
    s_waitcnt lgkmcnt(4)
    v_alignbit_b32 v48, v41, v40, 16
    v_alignbit_b32 v49, v42, v41, 16
    v_alignbit_b32 v50, v43, v42, 16
    v_alignbit_b32 v51, v44, v43, 16
    v_mov_b32 v52, v41
    v_mov_b32 v53, v42
    v_mov_b32 v54, v43
    v_mov_b32 v55, v44
    v_alignbit_b32 v56, v42, v41, 16
    v_alignbit_b32 v57, v43, v42, 16
    v_alignbit_b32 v58, v44, v43, 16
    v_alignbit_b32 v59, v45, v44, 16
    ds_write_b128 v7, v[40:43] offset:2048
    ds_write_b128 v7, v[48:51] offset:6208
    ds_write_b128 v7, v[52:55] offset:10368
    ds_write_b128 v7, v[56:59] offset:14528
    s_cmp_eq_u32 s18, 0
    s_cbranch_scc0 Lp1i_11
    v_and_b32 v62, 3, v2
    v_lshlrev_b32 v62, 6, v62
    s_mov_b64 exec, 0xf
    global_load_dword v63, v62, s[46:47] sc1
    s_mov_b64 exec, -1
Lp1i_11:
    v_mov_b32 v64, 0
    v_mov_b32 v65, 0
    v_mov_b32 v66, 0
    v_mov_b32 v67, 0
    v_lshrrev_b32 v9, 2, v0
    v_mul_u32_u24 v9, 4160, v9
    v_and_b32 v10, 3, v0
    v_lshlrev_b32 v10, 4, v10
    v_add_u32 v9, v9, v10
    v_add_u32 v9, 128000, v9
    v_cmp_gt_u32 vcc, 32, v0
    s_and_saveexec_b64 s[56:57], vcc
    s_cbranch_execz Lkg_z_12
    ds_write_b128 v9, v[64:67]
Lkg_z_12:
    s_mov_b64 exec, s[56:57]
    s_waitcnt lgkmcnt(0)
    s_lshr_b32 s53, s19, 2
    s_lshl_b32 s53, s53, 15
    s_and_b32 s54, s19, 3
    s_lshl_b32 s54, s54, 5
    s_add_u32 s53, s53, s54
    s_add_u32 s53, s53, 0
    v_lshlrev_b32 v46, 7, v0
    v_add_u32 v46, s53, v46
    v_lshlrev_b32 v47, 5, v0
    v_add_u32 v47, 2097152, v47
    s_cmp_eq_u32 s18, 0
    s_cbranch_scc0 Lp1c_13
    s_mov_b32 s56, 0
    s_mov_b64 exec, 0xf
Lp1l_14:
    s_waitcnt vmcnt(0)
    v_cmp_le_u32 vcc, 64, v63
    s_cmp_eq_u64 vcc, exec
    s_cbranch_scc1 Lp1d_15
    global_load_dword v63, v62, s[46:47] sc1
    s_add_u32 s56, s56, 1
    s_cmp_lt_u32 s56, 0x40000
    s_cbranch_scc1 Lp1l_14
    s_waitcnt vmcnt(0)
Lp1d_15:
    s_mov_b64 exec, -1
Lp1c_13:
    s_barrier
    global_load_dwordx4 v[24:27], v47, s[48:49]
    global_load_dwordx4 v[28:31], v47, s[48:49] offset:16
    global_load_dwordx4 v[16:19], v46, s[48:49]
    global_load_dwordx4 v[20:23], v46, s[48:49] offset:16
    s_mov_b32 s60, s36
    s_mov_b32 s61, s37
    s_mov_b32 s62, 1835008
    s_mov_b32 s63, 0x20000
    s_mul_i32 s64, s52, 224
    v_add_u32 v62, 0, v2
    v_mul_u32_u24 v63, 4682, v62
    v_lshrrev_b32 v63, 16, v63
    v_mul_u32_u24 v160, 14, v63
    v_sub_u32 v62, v62, v160
    v_mul_u32_u24 v63, 3584, v63
    v_lshlrev_b32 v62, 4, v62
    v_add3_u32 v160, v62, v63, s64
    v_add_u32 v62, 64, v2
    v_mul_u32_u24 v63, 4682, v62
    v_lshrrev_b32 v63, 16, v63
    v_mul_u32_u24 v161, 14, v63
    v_sub_u32 v62, v62, v161
    v_mul_u32_u24 v63, 3584, v63
    v_lshlrev_b32 v62, 4, v62
    v_add3_u32 v161, v62, v63, s64
    v_subrev_u32 v161, 1024, v161
    v_add_u32 v62, 128, v2
    v_mul_u32_u24 v63, 4682, v62
    v_lshrrev_b32 v63, 16, v63
    v_mul_u32_u24 v162, 14, v63
    v_sub_u32 v62, v62, v162
    v_mul_u32_u24 v63, 3584, v63
    v_lshlrev_b32 v62, 4, v62
    v_add3_u32 v162, v62, v63, s64
    v_subrev_u32 v162, 2048, v162
    v_add_u32 v62, 192, v2
    v_mul_u32_u24 v63, 4682, v62
    v_lshrrev_b32 v63, 16, v63
    v_mul_u32_u24 v163, 14, v63
    v_sub_u32 v62, v62, v163
    v_mul_u32_u24 v63, 3584, v63
    v_lshlrev_b32 v62, 4, v62
    v_add3_u32 v163, v62, v63, s64
    v_subrev_u32 v163, 3072, v163
    v_add_u32 v62, 256, v2
    v_mul_u32_u24 v63, 4682, v62
    v_lshrrev_b32 v63, 16, v63
    v_mul_u32_u24 v164, 14, v63
    v_sub_u32 v62, v62, v164
    v_mul_u32_u24 v63, 3584, v63
    v_lshlrev_b32 v62, 4, v62
    v_add3_u32 v164, v62, v63, s64
    v_add_u32 v62, 320, v2
    v_mul_u32_u24 v63, 4682, v62
    v_lshrrev_b32 v63, 16, v63
    v_mul_u32_u24 v165, 14, v63
    v_sub_u32 v62, v62, v165
    v_mul_u32_u24 v63, 3584, v63
    v_lshlrev_b32 v62, 4, v62
    v_add3_u32 v165, v62, v63, s64
    v_subrev_u32 v165, 1024, v165
    v_add_u32 v62, 384, v2
    v_mul_u32_u24 v63, 4682, v62
    v_lshrrev_b32 v63, 16, v63
    v_mul_u32_u24 v166, 14, v63
    v_sub_u32 v62, v62, v166
    v_mul_u32_u24 v63, 3584, v63
    v_lshlrev_b32 v62, 4, v62
    v_add3_u32 v166, v62, v63, s64
    v_subrev_u32 v166, 2048, v166
    s_mul_i32 s65, s18, 458752
    s_mul_i32 s68, s18, 28672
    s_mov_b32 s54, 0xffff0000
    v_min_u32 v62, 55, v2
    v_and_b32 v59, s54, v245
    v_lshlrev_b32 v58, 16, v245
    v_lshlrev_b32 v62, 3, v62
    v_add_u32 v62, 162816, v62
    ds_write_b64 v62, v[58:59]
    s_cmp_eq_u32 s70, 1
    s_cbranch_scc0 La_w2rd_16
    s_waitcnt vmcnt(5)
    v_lshrrev_b32 v46, 2, v2
    v_and_b32 v48, 1, v2
    v_lshlrev_b32 v48, 3, v48
    v_bfe_u32 v49, v2, 1, 1
    v_lshl_add_u32 v48, v49, 4, v48
    v_add_u32 v48, s69, v48
    s_cmp_eq_u32 s15, 0
    s_cbranch_scc0 La_w2m_17
    v_bfe_u32 v47, v2, 3, 2
    v_lshlrev_b32 v47, 1, v47
    v_mov_b32 v51, v47
    v_lshl_add_u32 v46, v46, 7, v48
    v_add_u32 v49, 2048, v46
    s_branch La_w2j_18
La_w2m_17:
    v_and_b32 v47, 2, v46
    v_add_u32 v51, 4, v47
    v_and_b32 v49, 3, v46
    v_bfe_u32 v50, v2, 4, 1
    v_lshl_add_u32 v49, v50, 3, v49
    v_lshl_add_u32 v46, v49, 7, v48
    v_lshrrev_b32 v50, 5, v2
    v_lshl_add_u32 v46, v50, 11, v46
    v_add_u32 v49, 512, v46
La_w2j_18:
    v_xor_b32 v50, 0, v47
    v_lshl_add_u32 v52, v50, 4, v46
    v_xor_b32 v50, 0, v51
    v_lshl_add_u32 v40, v50, 4, v49
    v_xor_b32 v50, 2, v47
    v_lshl_add_u32 v53, v50, 4, v46
    v_xor_b32 v50, 2, v51
    v_lshl_add_u32 v41, v50, 4, v49
    v_xor_b32 v50, 4, v47
    v_lshl_add_u32 v54, v50, 4, v46
    v_xor_b32 v50, 4, v51
    v_lshl_add_u32 v42, v50, 4, v49
    v_xor_b32 v50, 6, v47
    v_lshl_add_u32 v55, v50, 4, v46
    v_xor_b32 v50, 6, v51
    v_lshl_add_u32 v43, v50, 4, v49
    ds_read_b64_tr_b16 v[200:201], v52
    ds_read_b64_tr_b16 v[202:203], v40
    ds_read_b64_tr_b16 v[204:205], v53
    ds_read_b64_tr_b16 v[206:207], v41
    ds_read_b64_tr_b16 v[208:209], v54
    ds_read_b64_tr_b16 v[210:211], v42
    ds_read_b64_tr_b16 v[212:213], v55
    ds_read_b64_tr_b16 v[214:215], v43
    s_waitcnt lgkmcnt(0)
La_w2rd_16:
    s_mov_b32 exec_lo, 0xffffffff
    s_mov_b32 exec_hi, 0xffff
    global_load_dword v254, v167, s[36:37]
    s_mov_b64 exec, -1
    v_lshrrev_b32 v40, 2, v2
    v_and_b32 v43, 3, v2
    v_mul_u32_u24 v41, 224, v40
    v_lshlrev_b32 v44, 3, v43
    s_mul_i32 s53, s18, 28672
    v_add3_u32 v197, v41, v44, s53
    v_add_u32 v198, s53, v6
    v_lshrrev_b32 v41, 4, v2
    v_lshlrev_b32 v41, 4, v41
    s_mul_i32 s53, s18, 448
    s_add_u32 s53, s53, 160768
    v_add_u32 v199, s53, v41
    s_lshr_b32 s53, s18, 1
    s_and_b32 s54, s18, 1
    v_and_b32 v7, 15, v2
    v_lshrrev_b32 v8, 4, v2
    v_and_b32 v9, 3, v7
    v_sub_u32 v9, 3, v9
    v_mul_u32_u24 v9, 4160, v9
    v_lshrrev_b32 v10, 2, v7
    v_lshlrev_b32 v10, 3, v10
    v_sub_u32 v9, v9, v10
    v_lshrrev_b32 v10, 1, v8
    v_lshlrev_b32 v11, 5, v10
    v_sub_u32 v9, v9, v11
    v_and_b32 v11, 1, v8
    v_lshlrev_b32 v12, 4, v11
    v_add_u32 v9, v9, v12
    s_mul_i32 s55, s53, 16640
    s_lshl_b32 s56, s54, 9
    s_sub_u32 s55, s55, s56
    s_add_u32 s55, s55, 124472
    v_add_u32 v60, s55, v9
    v_mul_u32_u24 v11, 2304, v11
    v_sub_u32 v12, v7, v10
    v_add_u32 v12, 2, v12
    v_lshlrev_b32 v12, 4, v12
    s_mul_i32 s55, s53, 4608
    s_add_u32 s55, s55, 114688
    v_add3_u32 v61, v11, v12, s55
    v_and_b32 v9, 1, v0
    v_mul_u32_u24 v9, 2304, v9
    v_lshrrev_b32 v10, 1, v0
    v_lshlrev_b32 v10, 4, v10
    v_add3_u32 v9, v9, v10, 0
    v_add_u32 v9, 114944, v9
    v_mul_u32_u24 v10, 288, v8
    v_lshlrev_b32 v11, 4, v7
    s_mul_i32 s55, s18, 9216
    s_add_u32 s55, s55, 123904
    v_add3_u32 v10, v10, v11, s55
    s_mul_i32 s56, s54, 1152
    v_add_u32 v240, s56, v10
    s_mul_i32 s56, s54, 8064
    s_sub_u32 s56, 8064, s56
    v_add_u32 v241, s56, v10
    s_cmp_eq_u32 s54, 0
    s_cselect_b32 s13, 1.0, 0
    v_lshrrev_b32 v10, 5, v0
    v_mul_u32_u24 v10, 1152, v10
    v_and_b32 v11, 1, v0
    v_mul_u32_u24 v11, 576, v11
    v_bfe_u32 v12, v0, 1, 4
    v_lshlrev_b32 v12, 4, v12
    v_add3_u32 v10, v10, v11, v12
    v_add_u32 v242, 123904, v10
    s_lshl_b32 s55, s19, 13
    s_add_u32 s55, s55, 5242880
    v_lshlrev_b32 v11, 4, v0
    v_add_u32 v243, s55, v11
    v_add_u32 v244, 4096, v243
    s_lshl_b32 s55, s16, 12
    s_add_u32 s55, s55, 2162688
    v_lshlrev_b32 v247, 7, v2
    v_add_u32 v247, s55, v247
    s_mov_b32 s58, 0xffff0000
    ds_read_b64 a[0:1], v60 offset:3520
    ds_read_b64 a[2:3], v60 offset:3528
    ds_read_b64 a[4:5], v60 offset:3456
    ds_read_b64 a[6:7], v60 offset:3464
    ds_read_b64 a[8:9], v60 offset:3392
    ds_read_b64 a[10:11], v60 offset:3400
    ds_read_b64 a[12:13], v60 offset:3328
    ds_read_b64 a[14:15], v60 offset:3336
    ds_read_b64 a[16:17], v60 offset:3264
    ds_read_b64 a[18:19], v60 offset:3272
    ds_read_b64 a[20:21], v60 offset:3200
    ds_read_b64 a[22:23], v60 offset:3208
    ds_read_b64 a[24:25], v60 offset:3136
    ds_read_b64 a[26:27], v60 offset:3144
    ds_read_b64 a[28:29], v60 offset:3072
    ds_read_b64 a[30:31], v60 offset:3080
    ds_read_b64 a[32:33], v60 offset:2496
    ds_read_b64 a[34:35], v60 offset:2504
    ds_read_b64 a[36:37], v60 offset:2432
    ds_read_b64 a[38:39], v60 offset:2440
    ds_read_b64 a[40:41], v60 offset:2368
    ds_read_b64 a[42:43], v60 offset:2376
    ds_read_b64 a[44:45], v60 offset:2304
    ds_read_b64 a[46:47], v60 offset:2312
    ds_read_b64 a[48:49], v60 offset:2240
    ds_read_b64 a[50:51], v60 offset:2248
    ds_read_b64 a[52:53], v60 offset:2176
    ds_read_b64 a[54:55], v60 offset:2184
    ds_read_b64 a[56:57], v60 offset:2112
    ds_read_b64 a[58:59], v60 offset:2120
    ds_read_b64 a[60:61], v60 offset:2048
    ds_read_b64 a[62:63], v60 offset:2056
    s_waitcnt vmcnt(3)
    v_lshlrev_b32 v40, 16, v24
    v_lshlrev_b32 v41, 16, v25
    v_and_b32 v48, s58, v24
    v_and_b32 v49, s58, v25
    v_lshlrev_b32 v42, 16, v26
    v_lshlrev_b32 v43, 16, v27
    v_and_b32 v50, s58, v26
    v_and_b32 v51, s58, v27
    v_lshlrev_b32 v44, 16, v28
    v_lshlrev_b32 v45, 16, v29
    v_and_b32 v52, s58, v28
    v_and_b32 v53, s58, v29
    v_lshlrev_b32 v46, 16, v30
    v_lshlrev_b32 v47, 16, v31
    v_and_b32 v54, s58, v30
    v_and_b32 v55, s58, v31
    v_rcp_f32 v48, v48
    v_rcp_f32 v49, v49
    v_rcp_f32 v50, v50
    v_rcp_f32 v51, v51
    v_rcp_f32 v52, v52
    v_rcp_f32 v53, v53
    v_rcp_f32 v54, v54
    v_rcp_f32 v55, v55
    s_waitcnt vmcnt(1)
    v_lshlrev_b32 v168, 16, v16
    v_and_b32 v169, s58, v16
    v_lshlrev_b32 v170, 16, v17
    v_and_b32 v171, s58, v17
    v_lshlrev_b32 v172, 16, v18
    v_and_b32 v173, s58, v18
    v_lshlrev_b32 v174, 16, v19
    v_and_b32 v175, s58, v19
    v_lshlrev_b32 v176, 16, v20
    v_and_b32 v177, s58, v20
    v_lshlrev_b32 v178, 16, v21
    v_and_b32 v179, s58, v21
    v_lshlrev_b32 v180, 16, v22
    v_and_b32 v181, s58, v22
    v_lshlrev_b32 v182, 16, v23
    v_and_b32 v183, s58, v23
    v_pk_add_f32 v[64:65], v[168:169], v[40:41] neg_lo:[0,1] neg_hi:[0,1]
    v_pk_add_f32 v[66:67], v[170:171], v[42:43] neg_lo:[0,1] neg_hi:[0,1]
    v_pk_add_f32 v[68:69], v[172:173], v[44:45] neg_lo:[0,1] neg_hi:[0,1]
    v_pk_add_f32 v[70:71], v[174:175], v[46:47] neg_lo:[0,1] neg_hi:[0,1]
    v_pk_add_f32 v[72:73], v[176:177], v[40:41] neg_lo:[0,1] neg_hi:[0,1]
    v_pk_add_f32 v[74:75], v[178:179], v[42:43] neg_lo:[0,1] neg_hi:[0,1]
    v_pk_add_f32 v[76:77], v[180:181], v[44:45] neg_lo:[0,1] neg_hi:[0,1]
    v_pk_add_f32 v[78:79], v[182:183], v[46:47] neg_lo:[0,1] neg_hi:[0,1]
    v_pk_mul_f32 v[64:65], v[64:65], v[48:49]
    v_pk_mul_f32 v[66:67], v[66:67], v[50:51]
    v_pk_mul_f32 v[68:69], v[68:69], v[52:53]
    v_pk_mul_f32 v[70:71], v[70:71], v[54:55]
    v_pk_mul_f32 v[72:73], v[72:73], v[48:49]
    v_pk_mul_f32 v[74:75], v[74:75], v[50:51]
    v_pk_mul_f32 v[76:77], v[76:77], v[52:53]
    v_pk_mul_f32 v[78:79], v[78:79], v[54:55]
    v_cvt_pk_bf16_f32 v32, v64, v65
    v_cvt_pk_bf16_f32 v33, v66, v67
    v_cvt_pk_bf16_f32 v34, v68, v69
    v_cvt_pk_bf16_f32 v35, v70, v71
    v_cvt_pk_bf16_f32 v36, v72, v73
    v_cvt_pk_bf16_f32 v37, v74, v75
    v_cvt_pk_bf16_f32 v38, v76, v77
    v_cvt_pk_bf16_f32 v39, v78, v79
    ds_write_b128 v9, v[32:35]
    ds_write_b128 v9, v[36:39] offset:4608
    s_waitcnt lgkmcnt(0)
    s_barrier
    v_readfirstlane_b32 s50, v246
    s_nop 0
    s_lshl_b32 s66, s50, 16
    s_and_b32 s67, s50, 0xffff0000
    ds_read_b128 a[128:131], v61 offset:224
    ds_read_b128 a[132:135], v61 offset:192
    ds_read_b128 a[136:139], v61 offset:160
    ds_read_b128 a[140:143], v61 offset:128
    ds_read_b128 a[144:147], v61 offset:96
    s_waitcnt lgkmcnt(4)
    v_mfma_f32_16x16x32_bf16 v[128:131], a[0:3], a[128:131], 0
    ds_read_b128 a[148:151], v61 offset:64
    v_mfma_f32_16x16x32_bf16 v[136:139], a[32:35], a[128:131], 0
    ds_read_b128 a[152:155], v61 offset:32
    s_waitcnt lgkmcnt(5)
    v_mfma_f32_16x16x32_bf16 v[128:131], a[4:7], a[132:135], v[128:131]
    ds_read_b128 a[156:159], v61 offset:0
    v_mfma_f32_16x16x32_bf16 v[136:139], a[36:39], a[132:135], v[136:139]
    ds_read_b128 a[160:163], v61 offset:480
    s_waitcnt lgkmcnt(6)
    v_mfma_f32_16x16x32_bf16 v[128:131], a[8:11], a[136:139], v[128:131]
    ds_read_b64 a[64:65], v60 offset:1472
    v_mfma_f32_16x16x32_bf16 v[136:139], a[40:43], a[136:139], v[136:139]
    ds_read_b64 a[66:67], v60 offset:1480
    s_waitcnt lgkmcnt(7)
    v_mfma_f32_16x16x32_bf16 v[128:131], a[12:15], a[140:143], v[128:131]
    ds_read_b128 a[164:167], v61 offset:448
    v_mfma_f32_16x16x32_bf16 v[136:139], a[44:47], a[140:143], v[136:139]
    ds_read_b128 a[168:171], v61 offset:416
    s_waitcnt lgkmcnt(8)
    v_mfma_f32_16x16x32_bf16 v[128:131], a[16:19], a[144:147], v[128:131]
    ds_read_b128 a[172:175], v61 offset:384
    v_mfma_f32_16x16x32_bf16 v[136:139], a[48:51], a[144:147], v[136:139]
    ds_read_b64 a[68:69], v60 offset:1408
    s_waitcnt lgkmcnt(9)
    v_mfma_f32_16x16x32_bf16 v[128:131], a[20:23], a[148:151], v[128:131]
    ds_read_b64 a[70:71], v60 offset:1416
    v_mfma_f32_16x16x32_bf16 v[136:139], a[52:55], a[148:151], v[136:139]
    ds_read_b128 a[176:179], v61 offset:352
    s_waitcnt lgkmcnt(10)
    v_mfma_f32_16x16x32_bf16 v[128:131], a[24:27], a[152:155], v[128:131]
    ds_read_b128 a[180:183], v61 offset:320
    v_mfma_f32_16x16x32_bf16 v[136:139], a[56:59], a[152:155], v[136:139]
    ds_read_b128 a[184:187], v61 offset:288
    s_waitcnt lgkmcnt(11)
    v_mfma_f32_16x16x32_bf16 v[128:131], a[28:31], a[156:159], v[128:131]
    ds_read_b64 a[72:73], v60 offset:1344
    v_mfma_f32_16x16x32_bf16 v[136:139], a[60:63], a[156:159], v[136:139]
    ds_read_b64 a[74:75], v60 offset:1352
    s_waitcnt lgkmcnt(12)
    v_mfma_f32_16x16x32_bf16 v[132:135], a[0:3], a[160:163], 0
    ds_read_b128 a[188:191], v61 offset:256
    v_mfma_f32_16x16x32_bf16 v[140:143], a[32:35], a[160:163], 0
    ds_read_b128 a[192:195], v61 offset:736
    s_waitcnt lgkmcnt(11)
    v_mfma_f32_16x16x32_bf16 v[132:135], a[4:7], a[164:167], v[132:135]
    ds_read_b64 a[76:77], v60 offset:1280
    v_mfma_f32_16x16x32_bf16 v[140:143], a[36:39], a[164:167], v[140:143]
    ds_read_b64 a[78:79], v60 offset:1288
    s_waitcnt lgkmcnt(12)
    v_mfma_f32_16x16x32_bf16 v[132:135], a[8:11], a[168:171], v[132:135]
    ds_read_b128 a[196:199], v61 offset:704
    s_mov_b32 m0, s68
    s_nop 0
    buffer_load_dwordx4 v160, s[60:63], s65 offen offset:0 lds
    v_mfma_f32_16x16x32_bf16 v[140:143], a[40:43], a[168:171], v[140:143]
    ds_read_b128 a[200:203], v61 offset:672
    s_waitcnt lgkmcnt(13)
    v_mfma_f32_16x16x32_bf16 v[132:135], a[12:15], a[172:175], v[132:135]
    ds_read_b128 a[204:207], v61 offset:640
    v_mfma_f32_16x16x32_bf16 v[140:143], a[44:47], a[172:175], v[140:143]
    ds_read_b64 a[80:81], v60 offset:1216
    s_waitcnt lgkmcnt(12)
    v_mfma_f32_16x16x32_bf16 v[132:135], a[16:19], a[176:179], v[132:135]
    ds_read_b64 a[82:83], v60 offset:1224
    v_mfma_f32_16x16x32_bf16 v[140:143], a[48:51], a[176:179], v[140:143]
    ds_read_b128 a[208:211], v61 offset:608
    buffer_load_dwordx4 v161, s[60:63], s65 offen offset:1024 lds
    s_waitcnt lgkmcnt(13)
    v_mfma_f32_16x16x32_bf16 v[132:135], a[20:23], a[180:183], v[132:135]
    ds_read_b128 a[212:215], v61 offset:576
    v_mfma_f32_16x16x32_bf16 v[140:143], a[52:55], a[180:183], v[140:143]
    ds_read_b128 a[216:219], v61 offset:544
    s_waitcnt lgkmcnt(14)
    v_mfma_f32_16x16x32_bf16 v[132:135], a[24:27], a[184:187], v[132:135]
    ds_read_b64 a[84:85], v60 offset:1152
    v_mfma_f32_16x16x32_bf16 v[140:143], a[56:59], a[184:187], v[140:143]
    ds_read_b64 a[86:87], v60 offset:1160
    s_waitcnt lgkmcnt(13)
    v_mfma_f32_16x16x32_bf16 v[132:135], a[28:31], a[188:191], v[132:135]
    ds_read_b128 a[220:223], v61 offset:512
    buffer_load_dwordx4 v162, s[60:63], s65 offen offset:2048 lds
    v_mfma_f32_16x16x32_bf16 v[140:143], a[60:63], a[188:191], v[140:143]
    ds_read_b128 a[224:227], v61 offset:992
    s_waitcnt lgkmcnt(14)
    v_mfma_f32_16x16x32_bf16 v[136:139], a[0:3], a[192:195], v[136:139]
    ds_read_b64 a[88:89], v60 offset:1088
    v_mfma_f32_16x16x32_bf16 v[144:147], a[32:35], a[192:195], 0
    ds_read_b64 a[90:91], v60 offset:1096
    s_waitcnt lgkmcnt(13)
    v_mfma_f32_16x16x32_bf16 v[136:139], a[4:7], a[196:199], v[136:139]
    ds_read_b128 a[228:231], v61 offset:960
    v_mfma_f32_16x16x32_bf16 v[144:147], a[36:39], a[196:199], v[144:147]
    ds_read_b128 a[232:235], v61 offset:928
    buffer_load_dwordx4 v163, s[60:63], s65 offen offset:3072 lds
    s_waitcnt lgkmcnt(14)
    v_mfma_f32_16x16x32_bf16 v[136:139], a[8:11], a[200:203], v[136:139]
    ds_read_b128 a[236:239], v61 offset:896
    v_mfma_f32_16x16x32_bf16 v[144:147], a[40:43], a[200:203], v[144:147]
    ds_read_b64 a[92:93], v60 offset:1024
    s_waitcnt lgkmcnt(15)
    v_mfma_f32_16x16x32_bf16 v[136:139], a[12:15], a[204:207], v[136:139]
    ds_read_b64 a[94:95], v60 offset:1032
    v_mfma_f32_16x16x32_bf16 v[144:147], a[44:47], a[204:207], v[144:147]
    ds_read_b128 a[240:243], v61 offset:864
    s_waitcnt lgkmcnt(14)
    v_mfma_f32_16x16x32_bf16 v[136:139], a[16:19], a[208:211], v[136:139]
    ds_read_b128 a[244:247], v61 offset:832
    s_add_u32 m0, s68, 4096
    s_add_u32 s68, s68, 7168
    buffer_load_dwordx4 v164, s[60:63], s65 offen offset:0 lds
    v_mfma_f32_16x16x32_bf16 v[144:147], a[48:51], a[208:211], v[144:147]
    ds_read_b128 a[248:251], v61 offset:800
    s_waitcnt lgkmcnt(15)
    v_mfma_f32_16x16x32_bf16 v[136:139], a[20:23], a[212:215], v[136:139]
    ds_read_b64 a[96:97], v60 offset:448
    v_mfma_f32_16x16x32_bf16 v[144:147], a[52:55], a[212:215], v[144:147]
    ds_read_b64 a[98:99], v60 offset:456
    s_waitcnt lgkmcnt(15)
    v_mfma_f32_16x16x32_bf16 v[136:139], a[24:27], a[216:219], v[136:139]
    ds_read_b128 a[252:255], v61 offset:768
    v_mfma_f32_16x16x32_bf16 v[144:147], a[56:59], a[216:219], v[144:147]
    ds_read_b128 v[64:67], v61 offset:1248
    buffer_load_dwordx4 v165, s[60:63], s65 offen offset:1024 lds
    s_waitcnt lgkmcnt(15)
    v_mfma_f32_16x16x32_bf16 v[136:139], a[28:31], a[220:223], v[136:139]
    ds_read_b64 a[100:101], v60 offset:384
    v_mfma_f32_16x16x32_bf16 v[144:147], a[60:63], a[220:223], v[144:147]
    ds_read_b64 a[102:103], v60 offset:392
    s_waitcnt lgkmcnt(15)
    v_mfma_f32_16x16x32_bf16 v[140:143], a[0:3], a[224:227], v[140:143]
    ds_read_b128 v[68:71], v61 offset:1216
    v_mfma_f32_16x16x32_bf16 v[148:151], a[32:35], a[224:227], 0
    ds_read_b128 v[72:75], v61 offset:1184
    s_waitcnt lgkmcnt(15)
    v_mfma_f32_16x16x32_bf16 v[140:143], a[4:7], a[228:231], v[140:143]
    ds_read_b128 v[76:79], v61 offset:1152
    buffer_load_dwordx4 v166, s[60:63], s65 offen offset:2048 lds
    v_mfma_f32_16x16x32_bf16 v[148:151], a[36:39], a[228:231], v[148:151]
    ds_read_b64 a[104:105], v60 offset:320
    s_waitcnt lgkmcnt(15)
    v_mfma_f32_16x16x32_bf16 v[140:143], a[8:11], a[232:235], v[140:143]
    ds_read_b64 a[106:107], v60 offset:328
    v_mfma_f32_16x16x32_bf16 v[148:151], a[40:43], a[232:235], v[148:151]
    ds_read_b128 v[80:83], v61 offset:1120
    v_mfma_f32_16x16x32_bf16 v[140:143], a[12:15], a[236:239], v[140:143]
    ds_read_b128 v[84:87], v61 offset:1088
    v_mfma_f32_16x16x32_bf16 v[148:151], a[44:47], a[236:239], v[148:151]
    ds_read_b128 v[88:91], v61 offset:1056
    s_mov_b32 m0, s68
    s_add_u32 s65, s65, 114688
    buffer_load_dwordx4 v160, s[60:63], s65 offen offset:0 lds
    s_waitcnt lgkmcnt(15)
    v_mfma_f32_16x16x32_bf16 v[140:143], a[16:19], a[240:243], v[140:143]
    ds_read_b64 a[108:109], v60 offset:256
    v_mfma_f32_16x16x32_bf16 v[148:151], a[48:51], a[240:243], v[148:151]
    ds_read_b64 a[110:111], v60 offset:264
    v_mfma_f32_16x16x32_bf16 v[140:143], a[20:23], a[244:247], v[140:143]
    ds_read_b128 v[92:95], v61 offset:1024
    v_mfma_f32_16x16x32_bf16 v[148:151], a[52:55], a[244:247], v[148:151]
    ds_read_b128 v[96:99], v61 offset:1504
    s_waitcnt lgkmcnt(15)
    v_mfma_f32_16x16x32_bf16 v[140:143], a[24:27], a[248:251], v[140:143]
    ds_read_b64 a[112:113], v60 offset:192
    buffer_load_dwordx4 v161, s[60:63], s65 offen offset:1024 lds
    v_mfma_f32_16x16x32_bf16 v[148:151], a[56:59], a[248:251], v[148:151]
    ds_read_b64 a[114:115], v60 offset:200
    v_mfma_f32_16x16x32_bf16 v[140:143], a[28:31], a[252:255], v[140:143]
    ds_read_b128 v[100:103], v61 offset:1472
    v_mfma_f32_16x16x32_bf16 v[148:151], a[60:63], a[252:255], v[148:151]
    ds_read_b128 v[104:107], v61 offset:1440
    s_waitcnt lgkmcnt(15)
    v_mfma_f32_16x16x32_bf16 v[144:147], a[0:3], v[64:67], v[144:147]
    ds_read_b128 v[108:111], v61 offset:1408
    v_mfma_f32_16x16x32_bf16 v[152:155], a[32:35], v[64:67], 0
    ds_read_b64 a[116:117], v60 offset:128
    buffer_load_dwordx4 v162, s[60:63], s65 offen offset:2048 lds
    v_mfma_f32_16x16x32_bf16 v[144:147], a[4:7], v[68:71], v[144:147]
    ds_read_b64 a[118:119], v60 offset:136
    v_mfma_f32_16x16x32_bf16 v[152:155], a[36:39], v[68:71], v[152:155]
    ds_read_b128 v[112:115], v61 offset:1376
    s_waitcnt lgkmcnt(15)
    v_mfma_f32_16x16x32_bf16 v[144:147], a[8:11], v[72:75], v[144:147]
    ds_read_b128 v[116:119], v61 offset:1344
    v_mfma_f32_16x16x32_bf16 v[152:155], a[40:43], v[72:75], v[152:155]
    ds_read_b128 v[120:123], v61 offset:1312
    v_mfma_f32_16x16x32_bf16 v[144:147], a[12:15], v[76:79], v[144:147]
    ds_read_b64 a[120:121], v60 offset:64
    buffer_load_dwordx4 v163, s[60:63], s65 offen offset:3072 lds
    v_mfma_f32_16x16x32_bf16 v[152:155], a[44:47], v[76:79], v[152:155]
    ds_read_b64 a[122:123], v60 offset:72
    s_waitcnt lgkmcnt(15)
    v_mfma_f32_16x16x32_bf16 v[144:147], a[16:19], v[80:83], v[144:147]
    ds_read_b128 v[124:127], v61 offset:1280
    v_mfma_f32_16x16x32_bf16 v[152:155], a[48:51], v[80:83], v[152:155]
    ds_read_b128 v[64:67], v61 offset:1760
    v_mfma_f32_16x16x32_bf16 v[144:147], a[20:23], v[84:87], v[144:147]
    ds_read_b64 a[124:125], v60 offset:0
    v_mfma_f32_16x16x32_bf16 v[152:155], a[52:55], v[84:87], v[152:155]
    ds_read_b64 a[126:127], v60 offset:8
    s_add_u32 m0, s68, 4096
    s_add_u32 s68, s68, 7168
    buffer_load_dwordx4 v164, s[60:63], s65 offen offset:0 lds
    v_mfma_f32_16x16x32_bf16 v[144:147], a[24:27], v[88:91], v[144:147]
    ds_read_b128 v[68:71], v61 offset:1728
    v_mfma_f32_16x16x32_bf16 v[152:155], a[56:59], v[88:91], v[152:155]
    ds_read_b128 v[72:75], v61 offset:1696
    s_waitcnt lgkmcnt(15)
    v_mfma_f32_16x16x32_bf16 v[144:147], a[28:31], v[92:95], v[144:147]
    ds_read_b128 v[76:79], v61 offset:1664
    v_mfma_f32_16x16x32_bf16 v[152:155], a[60:63], v[92:95], v[152:155]
    ds_read_b128 v[80:83], v61 offset:1632
    v_mfma_f32_16x16x32_bf16 v[148:151], a[0:3], v[96:99], v[148:151]
    ds_read_b128 v[84:87], v61 offset:1600
    buffer_load_dwordx4 v165, s[60:63], s65 offen offset:1024 lds
    v_mfma_f32_16x16x32_bf16 v[156:159], a[32:35], v[96:99], 0
    ds_read_b128 v[88:91], v61 offset:1568
    v_mfma_f32_16x16x32_bf16 v[148:151], a[4:7], v[100:103], v[148:151]
    ds_read_b128 v[92:95], v61 offset:1536
    v_mfma_f32_16x16x32_bf16 v[156:159], a[36:39], v[100:103], v[156:159]
    ds_read_b128 v[96:99], v61 offset:2016
    s_waitcnt lgkmcnt(15)
    v_mfma_f32_16x16x32_bf16 v[148:151], a[8:11], v[104:107], v[148:151]
    ds_read_b128 v[100:103], v61 offset:1984
    v_mfma_f32_16x16x32_bf16 v[156:159], a[40:43], v[104:107], v[156:159]
    ds_read_b128 v[104:107], v61 offset:1952
    buffer_load_dwordx4 v166, s[60:63], s65 offen offset:2048 lds
    v_mfma_f32_16x16x32_bf16 v[148:151], a[12:15], v[108:111], v[148:151]
    v_mfma_f32_16x16x32_bf16 v[156:159], a[44:47], v[108:111], v[156:159]
    ds_read_b128 v[108:111], v61 offset:1920
    v_mfma_f32_16x16x32_bf16 v[148:151], a[16:19], v[112:115], v[148:151]
    v_mfma_f32_16x16x32_bf16 v[156:159], a[48:51], v[112:115], v[156:159]
    ds_read_b128 v[112:115], v61 offset:1888
    v_mfma_f32_16x16x32_bf16 v[148:151], a[20:23], v[116:119], v[148:151]
    s_mov_b32 m0, s68
    s_add_u32 s65, s65, 114688
    buffer_load_dwordx4 v160, s[60:63], s65 offen offset:0 lds
    v_mfma_f32_16x16x32_bf16 v[156:159], a[52:55], v[116:119], v[156:159]
    ds_read_b128 v[116:119], v61 offset:1856
    s_waitcnt lgkmcnt(15)
    v_mfma_f32_16x16x32_bf16 v[148:151], a[24:27], v[120:123], v[148:151]
    v_mfma_f32_16x16x32_bf16 v[156:159], a[56:59], v[120:123], v[156:159]
    ds_read_b128 v[120:123], v61 offset:1824
    v_mfma_f32_16x16x32_bf16 v[148:151], a[28:31], v[124:127], v[148:151]
    v_mfma_f32_16x16x32_bf16 v[156:159], a[60:63], v[124:127], v[156:159]
    ds_read_b128 v[124:127], v61 offset:1792
    buffer_load_dwordx4 v161, s[60:63], s65 offen offset:1024 lds
    v_mfma_f32_16x16x32_bf16 v[152:155], a[0:3], v[64:67], v[152:155]
    s_waitcnt lgkmcnt(14)
    v_mfma_f32_16x16x32_bf16 v[152:155], a[4:7], v[68:71], v[152:155]
    s_waitcnt lgkmcnt(13)
    v_mfma_f32_16x16x32_bf16 v[152:155], a[8:11], v[72:75], v[152:155]
    s_waitcnt lgkmcnt(12)
    v_mfma_f32_16x16x32_bf16 v[152:155], a[12:15], v[76:79], v[152:155]
    s_waitcnt lgkmcnt(11)
    v_mfma_f32_16x16x32_bf16 v[152:155], a[16:19], v[80:83], v[152:155]
    buffer_load_dwordx4 v162, s[60:63], s65 offen offset:2048 lds
    s_waitcnt lgkmcnt(10)
    v_mfma_f32_16x16x32_bf16 v[152:155], a[20:23], v[84:87], v[152:155]
    s_waitcnt lgkmcnt(9)
    v_mfma_f32_16x16x32_bf16 v[152:155], a[24:27], v[88:91], v[152:155]
    s_waitcnt lgkmcnt(8)
    v_mfma_f32_16x16x32_bf16 v[152:155], a[28:31], v[92:95], v[152:155]
    s_waitcnt lgkmcnt(7)
    v_mfma_f32_16x16x32_bf16 v[156:159], a[0:3], v[96:99], v[156:159]
    s_waitcnt lgkmcnt(6)
    v_mfma_f32_16x16x32_bf16 v[156:159], a[4:7], v[100:103], v[156:159]
    buffer_load_dwordx4 v163, s[60:63], s65 offen offset:3072 lds
    s_waitcnt lgkmcnt(5)
    v_mfma_f32_16x16x32_bf16 v[156:159], a[8:11], v[104:107], v[156:159]
    s_waitcnt lgkmcnt(4)
    v_mfma_f32_16x16x32_bf16 v[156:159], a[12:15], v[108:111], v[156:159]
    s_waitcnt lgkmcnt(3)
    v_mfma_f32_16x16x32_bf16 v[156:159], a[16:19], v[112:115], v[156:159]
    s_waitcnt lgkmcnt(2)
    v_mfma_f32_16x16x32_bf16 v[156:159], a[20:23], v[116:119], v[156:159]
    s_waitcnt lgkmcnt(1)
    v_mfma_f32_16x16x32_bf16 v[156:159], a[24:27], v[120:123], v[156:159]
    s_add_u32 m0, s68, 4096
    s_add_u32 s68, s68, 7168
    buffer_load_dwordx4 v164, s[60:63], s65 offen offset:0 lds
    s_waitcnt lgkmcnt(0)
    v_mfma_f32_16x16x32_bf16 v[156:159], a[28:31], v[124:127], v[156:159]
    s_waitcnt lgkmcnt(0)
    s_barrier
    v_mfma_f32_16x16x32_bf16 v[144:147], a[64:67], a[128:131], v[144:147]
    v_lshlrev_b32 v56, 16, v32
    v_and_b32 v57, s58, v32
    v_mfma_f32_16x16x32_bf16 v[152:155], a[96:99], a[128:131], v[152:155]
    ds_write_b128 v240, v[128:131] offset:0
    v_mfma_f32_16x16x32_bf16 v[144:147], a[68:71], a[132:135], v[144:147]
    v_fmac_f32 v168, s66, v56
    v_fmac_f32 v169, s66, v57
    v_mfma_f32_16x16x32_bf16 v[152:155], a[100:103], a[132:135], v[152:155]
    buffer_load_dwordx4 v165, s[60:63], s65 offen offset:1024 lds
    v_mfma_f32_16x16x32_bf16 v[144:147], a[72:75], a[136:139], v[144:147]
    ds_write_b128 v240, v[132:135] offset:1152
    v_mfma_f32_16x16x32_bf16 v[152:155], a[104:107], a[136:139], v[152:155]
    v_lshlrev_b32 v56, 16, v33
    v_and_b32 v57, s58, v33
    v_mfma_f32_16x16x32_bf16 v[144:147], a[76:79], a[140:143], v[144:147]
    v_fmac_f32 v170, s66, v56
    v_fmac_f32 v171, s66, v57
    v_mfma_f32_16x16x32_bf16 v[152:155], a[108:111], a[140:143], v[152:155]
    ds_write_b128 v240, v[136:139] offset:2304
    v_mfma_f32_16x16x32_bf16 v[144:147], a[80:83], a[144:147], v[144:147]
    buffer_load_dwordx4 v166, s[60:63], s65 offen offset:2048 lds
    v_mfma_f32_16x16x32_bf16 v[152:155], a[112:115], a[144:147], v[152:155]
    v_lshlrev_b32 v56, 16, v34
    v_and_b32 v57, s58, v34
    v_mfma_f32_16x16x32_bf16 v[144:147], a[84:87], a[148:151], v[144:147]
    ds_write_b128 v240, v[140:143] offset:3456
    v_mfma_f32_16x16x32_bf16 v[152:155], a[116:119], a[148:151], v[152:155]
    v_fmac_f32 v172, s66, v56
    v_fmac_f32 v173, s66, v57
    v_mfma_f32_16x16x32_bf16 v[144:147], a[88:91], a[152:155], v[144:147]
    v_lshlrev_b32 v56, 16, v35
    v_and_b32 v57, s58, v35
    v_mfma_f32_16x16x32_bf16 v[152:155], a[120:123], a[152:155], v[152:155]
    s_mov_b32 m0, s68
    s_add_u32 s65, s65, 114688
    buffer_load_dwordx4 v160, s[60:63], s65 offen offset:0 lds
    v_mfma_f32_16x16x32_bf16 v[144:147], a[92:95], a[156:159], v[144:147]
    v_fmac_f32 v174, s66, v56
    v_fmac_f32 v175, s66, v57
    v_mfma_f32_16x16x32_bf16 v[152:155], a[124:127], a[156:159], v[152:155]
    v_lshlrev_b32 v56, 16, v36
    v_and_b32 v57, s58, v36
    v_mfma_f32_16x16x32_bf16 v[148:151], a[64:67], a[160:163], v[148:151]
    v_fmac_f32 v176, s67, v56
    v_fmac_f32 v177, s67, v57
    v_mfma_f32_16x16x32_bf16 v[156:159], a[96:99], a[160:163], v[156:159]
    v_lshlrev_b32 v56, 16, v37
    v_and_b32 v57, s58, v37
    v_mfma_f32_16x16x32_bf16 v[148:151], a[68:71], a[164:167], v[148:151]
    buffer_load_dwordx4 v161, s[60:63], s65 offen offset:1024 lds
    v_mfma_f32_16x16x32_bf16 v[156:159], a[100:103], a[164:167], v[156:159]
    ds_write_b128 v240, v[144:147] offset:4608
    v_mfma_f32_16x16x32_bf16 v[148:151], a[72:75], a[168:171], v[148:151]
    v_fmac_f32 v178, s67, v56
    v_fmac_f32 v179, s67, v57
    v_mfma_f32_16x16x32_bf16 v[156:159], a[104:107], a[168:171], v[156:159]
    v_lshlrev_b32 v56, 16, v38
    v_and_b32 v57, s58, v38
    v_mfma_f32_16x16x32_bf16 v[148:151], a[76:79], a[172:175], v[148:151]
    v_fmac_f32 v180, s67, v56
    v_fmac_f32 v181, s67, v57
    v_mfma_f32_16x16x32_bf16 v[156:159], a[108:111], a[172:175], v[156:159]
    buffer_load_dwordx4 v162, s[60:63], s65 offen offset:2048 lds
    v_mfma_f32_16x16x32_bf16 v[148:151], a[80:83], a[176:179], v[148:151]
    v_lshlrev_b32 v56, 16, v39
    v_and_b32 v57, s58, v39
    v_mfma_f32_16x16x32_bf16 v[156:159], a[112:115], a[176:179], v[156:159]
    v_fmac_f32 v182, s67, v56
    v_fmac_f32 v183, s67, v57
    v_mfma_f32_16x16x32_bf16 v[148:151], a[84:87], a[180:183], v[148:151]
    v_mfma_f32_16x16x32_bf16 v[156:159], a[116:119], a[180:183], v[156:159]
    v_mfma_f32_16x16x32_bf16 v[148:151], a[88:91], a[184:187], v[148:151]
    buffer_load_dwordx4 v163, s[60:63], s65 offen offset:3072 lds
    v_mfma_f32_16x16x32_bf16 v[156:159], a[120:123], a[184:187], v[156:159]
    v_mfma_f32_16x16x32_bf16 v[148:151], a[92:95], a[188:191], v[148:151]
    v_mfma_f32_16x16x32_bf16 v[156:159], a[124:127], a[188:191], v[156:159]
    v_mfma_f32_16x16x32_bf16 v[152:155], a[64:67], a[192:195], v[152:155]
    v_mfma_f32_16x16x32_bf16 v[152:155], a[68:71], a[196:199], v[152:155]
    s_add_u32 m0, s68, 4096
    s_add_u32 s68, s68, 7168
    buffer_load_dwordx4 v164, s[60:63], s65 offen offset:0 lds
    v_mfma_f32_16x16x32_bf16 v[152:155], a[72:75], a[200:203], v[152:155]
    v_mfma_f32_16x16x32_bf16 v[152:155], a[76:79], a[204:207], v[152:155]
    ds_write_b128 v240, v[148:151] offset:5760
    v_mfma_f32_16x16x32_bf16 v[152:155], a[80:83], a[208:211], v[152:155]
    v_mfma_f32_16x16x32_bf16 v[152:155], a[84:87], a[212:215], v[152:155]
    v_mfma_f32_16x16x32_bf16 v[152:155], a[88:91], a[216:219], v[152:155]
    buffer_load_dwordx4 v165, s[60:63], s65 offen offset:1024 lds
    v_mfma_f32_16x16x32_bf16 v[152:155], a[92:95], a[220:223], v[152:155]
    v_mfma_f32_16x16x32_bf16 v[156:159], a[64:67], a[224:227], v[156:159]
    v_mfma_f32_16x16x32_bf16 v[156:159], a[68:71], a[228:231], v[156:159]
    v_mfma_f32_16x16x32_bf16 v[156:159], a[72:75], a[232:235], v[156:159]
    v_mfma_f32_16x16x32_bf16 v[156:159], a[76:79], a[236:239], v[156:159]
    buffer_load_dwordx4 v166, s[60:63], s65 offen offset:2048 lds
    v_mfma_f32_16x16x32_bf16 v[156:159], a[80:83], a[240:243], v[156:159]
    ds_write_b128 v240, v[152:155] offset:6912
    v_mfma_f32_16x16x32_bf16 v[156:159], a[84:87], a[244:247], v[156:159]
    v_mfma_f32_16x16x32_bf16 v[156:159], a[88:91], a[248:251], v[156:159]
    v_mfma_f32_16x16x32_bf16 v[156:159], a[92:95], a[252:255], v[156:159]
    s_cmp_eq_u32 s70, 1
    s_cbranch_scc0 La_w2st_19
    s_mul_i32 s55, s72, 224
    s_add_u32 s55, s55, s71
    s_lshl_b32 s55, s55, 10
    s_add_u32 s55, s55, 3145728
    v_add_u32 v216, s55, v6
    global_store_dwordx4 v216, v[200:203], s[48:49] sc1
    v_add_u32 v216, 57344, v216
    global_store_dwordx4 v216, v[204:207], s[48:49] sc1
    v_add_u32 v216, 57344, v216
    global_store_dwordx4 v216, v[208:211], s[48:49] sc1
    v_add_u32 v216, 57344, v216
    global_store_dwordx4 v216, v[212:215], s[48:49] sc1
La_w2st_19:
    s_nop 6
    v_mul_f32 v156, s13, v156
    v_mul_f32 v157, s13, v157
    v_mul_f32 v158, s13, v158
    v_mul_f32 v159, s13, v159
    ds_write_b128 v241, v[156:159]
    s_waitcnt lgkmcnt(0)
    s_barrier
    ds_read_b128 v[64:67], v242 offset:0
    ds_read_b128 v[68:71], v242 offset:288
    ds_read_b128 v[72:75], v242 offset:9216
    ds_read_b128 v[76:79], v242 offset:9504
    ds_read_b128 v[80:83], v242 offset:18432
    ds_read_b128 v[84:87], v242 offset:18720
    ds_read_b128 v[88:91], v242 offset:27648
    ds_read_b128 v[92:95], v242 offset:27936
    s_waitcnt lgkmcnt(4)
    v_pk_add_f32 v[64:65], v[64:65], v[72:73]
    v_pk_add_f32 v[66:67], v[66:67], v[74:75]
    v_pk_add_f32 v[68:69], v[68:69], v[76:77]
    v_pk_add_f32 v[70:71], v[70:71], v[78:79]
    v_pk_add_f32 v[64:65], v[64:65], v[168:169]
    v_pk_add_f32 v[66:67], v[66:67], v[170:171]
    v_pk_add_f32 v[68:69], v[68:69], v[172:173]
    v_pk_add_f32 v[70:71], v[70:71], v[174:175]
    v_cvt_pk_bf16_f32 v108, v64, v65
    v_cvt_pk_bf16_f32 v109, v66, v67
    v_cvt_pk_bf16_f32 v110, v68, v69
    v_cvt_pk_bf16_f32 v111, v70, v71
    global_store_dwordx4 v243, v[108:111], s[48:49] sc1
    s_waitcnt lgkmcnt(0)
    v_pk_add_f32 v[80:81], v[80:81], v[88:89]
    v_pk_add_f32 v[82:83], v[82:83], v[90:91]
    v_pk_add_f32 v[84:85], v[84:85], v[92:93]
    v_pk_add_f32 v[86:87], v[86:87], v[94:95]
    v_pk_add_f32 v[80:81], v[80:81], v[176:177]
    v_pk_add_f32 v[82:83], v[82:83], v[178:179]
    v_pk_add_f32 v[84:85], v[84:85], v[180:181]
    v_pk_add_f32 v[86:87], v[86:87], v[182:183]
    v_cvt_pk_bf16_f32 v112, v80, v81
    v_cvt_pk_bf16_f32 v113, v82, v83
    v_cvt_pk_bf16_f32 v114, v84, v85
    v_cvt_pk_bf16_f32 v115, v86, v87
    global_store_dwordx4 v244, v[112:115], s[48:49] sc1
    v_mov_b32 v4, 1
    s_waitcnt vmcnt(0)
    s_barrier
    s_cmp_eq_u32 s18, 0
    s_cbranch_scc0 Larr_20
    s_mov_b32 exec_lo, 0xffff
    s_mov_b32 exec_hi, 0x0
    global_atomic_add v247, v4, s[48:49] sc1
    s_mov_b64 exec, -1
Larr_20:
    v_mov_b32 v24, 0x3f803f80
    v_mov_b32 v25, 0x3f803f80
    v_mov_b32 v26, 0x3f803f80
    v_mov_b32 v27, 0x3f803f80
    v_mov_b32 v60, 0
    v_mov_b32 v61, 0
    v_mov_b32 v62, 0
    v_mov_b32 v63, 0
    ds_read_b64_tr_b16 v[128:129], v197 offset:0
    ds_read_b64_tr_b16 v[130:131], v197 offset:3584
    ds_read_b64_tr_b16 v[132:133], v197 offset:32
    ds_read_b64_tr_b16 v[134:135], v197 offset:3616
    ds_read_b64_tr_b16 v[136:137], v197 offset:64
    ds_read_b64_tr_b16 v[138:139], v197 offset:3648
    ds_read_b64_tr_b16 v[140:141], v197 offset:96
    ds_read_b64_tr_b16 v[142:143], v197 offset:3680
    ds_read_b64_tr_b16 v[144:145], v197 offset:128
    ds_read_b64_tr_b16 v[146:147], v197 offset:3712
    ds_read_b64_tr_b16 v[148:149], v197 offset:160
    ds_read_b64_tr_b16 v[150:151], v197 offset:3744
    ds_read_b64_tr_b16 v[152:153], v197 offset:192
    ds_read_b64_tr_b16 v[154:155], v197 offset:3776
    s_and_b32 s53, s17, 15
    s_lshl_b32 s53, s53, 7
    s_add_u32 s53, s53, 2162688
    v_min_u32 v28, 7, v2
    v_lshlrev_b32 v28, 12, v28
    v_add_u32 v28, s53, v28
    s_and_b32 s53, s52, 7
    s_lshl_b32 s53, s53, 7
    v_mov_b32 v250, s53
    global_load_dword v254, v250, s[42:43]
    s_waitcnt lgkmcnt(0)
    ds_read_b64_tr_b16 v[156:157], v197 offset:7168
    ds_read_b64_tr_b16 v[158:159], v197 offset:10752
    ds_read_b64_tr_b16 v[160:161], v197 offset:7200
    ds_read_b64_tr_b16 v[162:163], v197 offset:10784
    ds_read_b64_tr_b16 v[164:165], v197 offset:7232
    ds_read_b64_tr_b16 v[166:167], v197 offset:10816
    ds_read_b64_tr_b16 v[168:169], v197 offset:7264
    ds_read_b64_tr_b16 v[170:171], v197 offset:10848
    ds_read_b64_tr_b16 v[172:173], v197 offset:7296
    ds_read_b64_tr_b16 v[174:175], v197 offset:10880
    ds_read_b64_tr_b16 v[176:177], v197 offset:7328
    ds_read_b64_tr_b16 v[178:179], v197 offset:10912
    ds_read_b64_tr_b16 v[180:181], v197 offset:7360
    ds_read_b64_tr_b16 v[182:183], v197 offset:10944
    v_mfma_f32_16x16x32_bf16 v[32:35], v[128:131], v[24:27], 0
    ds_write_b128 v198, v[128:131] offset:0
    s_add_u32 s20, s48, 5242880
    s_addc_u32 s21, s49, 0
    s_mov_b32 s22, 2097152
    s_mov_b32 s23, 0x20000
    v_lshrrev_b32 v3, 2, v2
    v_lshlrev_b32 v250, 12, v3
    v_mfma_f32_16x16x32_bf16 v[36:39], v[132:135], v[24:27], 0
    ds_write_b128 v198, v[132:135] offset:1024
    v_bfe_u32 v5, v2, 4, 1
    v_lshlrev_b32 v5, 1, v5
    v_and_b32 v4, 3, v2
    v_xor_b32 v251, v4, v5
    v_lshlrev_b32 v251, 4, v251
    s_lshl_b32 s10, s51, 8
    v_mfma_f32_16x16x32_bf16 v[40:43], v[136:139], v[24:27], 0
    ds_write_b128 v198, v[136:139] offset:2048
    s_lshl_b32 s11, s18, 6
    s_add_u32 s10, s10, s11
    v_add3_u32 v184, v250, v251, s10
    v_add_u32 v224, 0, v184
    v_add_u32 v225, 64512, v184
    v_add_u32 v226, 131072, v184
    v_mfma_f32_16x16x32_bf16 v[44:47], v[140:143], v[24:27], 0
    ds_write_b128 v198, v[140:143] offset:3072
    v_add_u32 v227, 195584, v184
    v_add_u32 v228, 262144, v184
    v_add_u32 v229, 326656, v184
    v_add_u32 v230, 393216, v184
    v_add_u32 v231, 457728, v184
    s_mul_i32 s11, s18, 10240
    v_mfma_f32_16x16x32_bf16 v[48:51], v[144:147], v[24:27], 0
    ds_write_b128 v198, v[144:147] offset:4096
    s_add_u32 s28, s11, 114688
    v_lshlrev_b32 v250, 6, v3
    v_and_b32 v251, 1, v4
    v_lshlrev_b32 v251, 3, v251
    v_add3_u32 v250, v250, v251, s28
    v_lshrrev_b32 v4, 1, v4
    v_mfma_f32_16x16x32_bf16 v[52:55], v[148:151], v[24:27], 0
    ds_write_b128 v198, v[148:151] offset:5120
    v_add_u32 v251, 0, v4
    v_xor_b32 v251, v251, v5
    v_lshl_add_u32 v186, v251, 4, v250
    v_add_u32 v251, 2, v4
    v_xor_b32 v251, v251, v5
    v_lshl_add_u32 v187, v251, 4, v250
    v_mfma_f32_16x16x32_bf16 v[56:59], v[152:155], v[24:27], 0
    ds_write_b128 v198, v[152:155] offset:6144
    s_and_b32 s29, s52, 7
    s_lshr_b32 s30, s52, 3
    s_lshl_b32 s10, s51, 1
    s_add_u32 s30, s30, s10
    s_lshr_b32 s31, s52, 2
    s_add_u32 s10, s31, 0
    s_waitcnt lgkmcnt(7)
    ds_read_b64_tr_b16 v[128:129], v197 offset:14336
    ds_read_b64_tr_b16 v[130:131], v197 offset:17920
    ds_read_b64_tr_b16 v[132:133], v197 offset:14368
    ds_read_b64_tr_b16 v[134:135], v197 offset:17952
    ds_read_b64_tr_b16 v[136:137], v197 offset:14400
    ds_read_b64_tr_b16 v[138:139], v197 offset:17984
    ds_read_b64_tr_b16 v[140:141], v197 offset:14432
    ds_read_b64_tr_b16 v[142:143], v197 offset:18016
    ds_read_b64_tr_b16 v[144:145], v197 offset:14464
    ds_read_b64_tr_b16 v[146:147], v197 offset:18048
    ds_read_b64_tr_b16 v[148:149], v197 offset:14496
    ds_read_b64_tr_b16 v[150:151], v197 offset:18080
    ds_read_b64_tr_b16 v[152:153], v197 offset:14528
    ds_read_b64_tr_b16 v[154:155], v197 offset:18112
    v_mfma_f32_16x16x32_bf16 v[32:35], v[156:159], v[24:27], v[32:35]
    ds_write_b128 v198, v[156:159] offset:7168
    s_and_b32 s10, s10, 3
    s_mul_i32 s11, s10, 28672
    v_add_u32 v188, s11, v6
    s_lshl_b32 s24, s10, 19
    s_add_u32 s10, s31, 1
    s_and_b32 s10, s10, 3
    v_mfma_f32_16x16x32_bf16 v[36:39], v[160:163], v[24:27], v[36:39]
    ds_write_b128 v198, v[160:163] offset:8192
    s_mul_i32 s11, s10, 28672
    v_add_u32 v189, s11, v6
    s_lshl_b32 s25, s10, 19
    s_add_u32 s10, s31, 2
    s_and_b32 s10, s10, 3
    s_mul_i32 s11, s10, 28672
    v_mfma_f32_16x16x32_bf16 v[40:43], v[164:167], v[24:27], v[40:43]
    ds_write_b128 v198, v[164:167] offset:9216
    v_add_u32 v190, s11, v6
    s_lshl_b32 s26, s10, 19
    s_add_u32 s10, s31, 3
    s_and_b32 s10, s10, 3
    s_mul_i32 s11, s10, 28672
    v_add_u32 v191, s11, v6
    v_mfma_f32_16x16x32_bf16 v[44:47], v[168:171], v[24:27], v[44:47]
    ds_write_b128 v198, v[168:171] offset:10240
    s_lshl_b32 s27, s10, 19
    v_and_b32 v250, 15, v2
    s_lshl_b32 s10, s18, 4
    v_add_u32 v250, s10, v250
    v_lshrrev_b32 v251, 1, v250
    s_lshl_b32 s10, s52, 5
    v_mfma_f32_16x16x32_bf16 v[48:51], v[172:175], v[24:27], v[48:51]
    ds_write_b128 v198, v[172:175] offset:11264
    v_add_u32 v251, s10, v251
    v_lshlrev_b32 v251, 12, v251
    v_and_b32 v250, 1, v250
    v_lshlrev_b32 v250, 7, v250
    s_lshl_b32 s10, s51, 8
    s_add_u32 s10, s10, 5242880
    v_mfma_f32_16x16x32_bf16 v[52:55], v[176:179], v[24:27], v[52:55]
    ds_write_b128 v198, v[176:179] offset:12288
    v_add3_u32 v196, v251, v250, s10
    s_mul_i32 s10, s29, 224
    s_mul_i32 s11, s18, 14
    s_add_u32 s10, s10, s11
    s_lshl_b32 s10, s10, 10
    s_add_u32 s10, s10, 3145728
    v_mfma_f32_16x16x32_bf16 v[56:59], v[180:183], v[24:27], v[56:59]
    ds_write_b128 v198, v[180:183] offset:13312
    s_lshr_b32 s12, s52, 3
    s_lshl_b32 s12, s12, 1
    s_xor_b32 s11, s12, 0
    s_mul_i32 s11, s11, 57344
    s_add_u32 s11, s11, s10
    v_add_u32 v192, s11, v6
    s_waitcnt lgkmcnt(7)
    ds_read_b64_tr_b16 v[156:157], v197 offset:21504
    ds_read_b64_tr_b16 v[158:159], v197 offset:25088
    ds_read_b64_tr_b16 v[160:161], v197 offset:21536
    ds_read_b64_tr_b16 v[162:163], v197 offset:25120
    ds_read_b64_tr_b16 v[164:165], v197 offset:21568
    ds_read_b64_tr_b16 v[166:167], v197 offset:25152
    ds_read_b64_tr_b16 v[168:169], v197 offset:21600
    ds_read_b64_tr_b16 v[170:171], v197 offset:25184
    ds_read_b64_tr_b16 v[172:173], v197 offset:21632
    ds_read_b64_tr_b16 v[174:175], v197 offset:25216
    ds_read_b64_tr_b16 v[176:177], v197 offset:21664
    ds_read_b64_tr_b16 v[178:179], v197 offset:25248
    ds_read_b64_tr_b16 v[180:181], v197 offset:21696
    ds_read_b64_tr_b16 v[182:183], v197 offset:25280
    v_mfma_f32_16x16x32_bf16 v[32:35], v[128:131], v[24:27], v[32:35]
    ds_write_b128 v198, v[128:131] offset:14336
    s_xor_b32 s11, s12, 1
    s_mul_i32 s11, s11, 57344
    s_add_u32 s11, s11, s10
    v_add_u32 v193, s11, v6
    s_xor_b32 s11, s12, 2
    s_mul_i32 s11, s11, 57344
    v_mfma_f32_16x16x32_bf16 v[36:39], v[132:135], v[24:27], v[36:39]
    ds_write_b128 v198, v[132:135] offset:15360
    s_add_u32 s11, s11, s10
    v_add_u32 v194, s11, v6
    s_xor_b32 s11, s12, 3
    s_mul_i32 s11, s11, 57344
    s_add_u32 s11, s11, s10
    v_add_u32 v195, s11, v6
    v_mfma_f32_16x16x32_bf16 v[40:43], v[136:139], v[24:27], v[40:43]
    ds_write_b128 v198, v[136:139] offset:16384
    v_lshrrev_b32 v250, 4, v2
    v_lshlrev_b32 v250, 10, v250
    v_and_b32 v251, 15, v2
    v_lshlrev_b32 v251, 3, v251
    s_lshl_b32 s10, s51, 12
    s_lshl_b32 s11, s18, 8
    v_mfma_f32_16x16x32_bf16 v[44:47], v[140:143], v[24:27], v[44:47]
    ds_write_b128 v198, v[140:143] offset:17408
    s_add_u32 s10, s10, s11
    s_add_u32 s10, s10, 2228224
    v_add3_u32 v232, v250, v251, s10
    v_lshrrev_b32 v250, 4, v2
    v_mul_u32_u24 v239, 448, v250
    v_and_b32 v251, 15, v2
    v_mfma_f32_16x16x32_bf16 v[48:51], v[144:147], v[24:27], v[48:51]
    ds_write_b128 v198, v[144:147] offset:18432
    v_lshlrev_b32 v251, 2, v251
    v_add_u32 v239, v239, v251
    v_add_u32 v239, 160768, v239
    v_lshlrev_b32 v250, 4, v250
    v_add_u32 v248, 162816, v250
    v_mov_b32 v249, 1.0
    v_mfma_f32_16x16x32_bf16 v[52:55], v[148:151], v[24:27], v[52:55]
    ds_write_b128 v198, v[148:151] offset:19456
    s_lshl_b32 s10, s51, 3
    s_lshl_b32 s11, s18, 1
    s_add_u32 s10, s10, s11
    s_mul_i32 s10, s10, 57344
    s_mul_i32 s11, s52, 3584
    s_add_u32 s10, s10, s11
    v_mfma_f32_16x16x32_bf16 v[56:59], v[152:155], v[24:27], v[56:59]
    ds_write_b128 v198, v[152:155] offset:20480
    s_add_u32 s10, s10, 8388608
    v_add_u32 v233, s10, v6
    v_add_u32 v234, 57344, v233
    v_lshrrev_b32 v250, 5, v2
    v_lshlrev_b32 v250, 8, v250
    v_and_b32 v251, 15, v2
    s_cmp_eq_u32 s18, 0
    s_cbranch_scc0 Lp2i_21
    s_mov_b64 s[54:55], exec
    s_mov_b64 exec, 0xff
    global_load_dword v29, v28, s[48:49] sc1
    s_mov_b64 exec, s[54:55]
Lp2i_21:
    s_waitcnt lgkmcnt(7)
    v_mfma_f32_16x16x32_bf16 v[32:35], v[156:159], v[24:27], v[32:35]
    ds_write_b128 v198, v[156:159] offset:21504
    v_lshl_add_u32 v250, v251, 4, v250
    v_bfe_u32 v251, v2, 4, 1
    v_lshl_add_u32 v250, v251, 3, v250
    s_add_u32 s10, s10, 3072
    v_add_u32 v235, s10, v250
    v_add_u32 v236, 57344, v235
    v_mfma_f32_16x16x32_bf16 v[36:39], v[160:163], v[24:27], v[36:39]
    ds_write_b128 v198, v[160:163] offset:22528
    v_lshrrev_b32 v250, 3, v2
    v_lshlrev_b32 v250, 12, v250
    v_and_b32 v251, 7, v2
    v_lshlrev_b32 v251, 4, v251
    s_lshl_b32 s10, s30, 7
    v_add3_u32 v237, v250, v251, s10
    v_mfma_f32_16x16x32_bf16 v[40:43], v[164:167], v[24:27], v[40:43]
    ds_write_b128 v198, v[164:167] offset:23552
    s_lshl_b32 s10, s29, 18
    s_xor_b32 s11, s18, s12
    s_lshl_b32 s11, s11, 16
    s_add_u32 s8, s10, s11
    s_add_u32 s9, s8, 32768
    v_lshrrev_b32 v250, 4, v2
    v_mfma_f32_16x16x32_bf16 v[44:47], v[168:171], v[24:27], v[44:47]
    ds_write_b128 v198, v[168:171] offset:24576
    v_lshlrev_b32 v250, 3, v250
    s_lshl_b32 s10, s29, 7
    s_lshl_b32 s11, s12, 5
    s_add_u32 s10, s10, s11
    v_add_u32 v238, s10, v250
    v_xor_b32 v7, 64, v238
    v_mfma_f32_16x16x32_bf16 v[48:51], v[172:175], v[24:27], v[48:51]
    ds_write_b128 v198, v[172:175] offset:25600
    v_mfma_f32_16x16x32_bf16 v[52:55], v[176:179], v[24:27], v[52:55]
    ds_write_b128 v198, v[176:179] offset:26624
    v_mfma_f32_16x16x32_bf16 v[56:59], v[180:183], v[24:27], v[56:59]
    ds_write_b128 v198, v[180:183] offset:27648
    s_mov_b64 s[56:57], exec
    s_mov_b32 exec_lo, 0x00010001
    s_mov_b32 exec_hi, 0x00010001
    s_nop 4
    ds_write_b128 v199, v[32:35] offset:0
    ds_write_b128 v199, v[36:39] offset:64
    ds_write_b128 v199, v[40:43] offset:128
    ds_write_b128 v199, v[44:47] offset:192
    ds_write_b128 v199, v[48:51] offset:256
    ds_write_b128 v199, v[52:55] offset:320
    ds_write_b128 v199, v[56:59] offset:384
    s_mov_b64 exec, s[56:57]
    s_cmp_eq_u32 s18, 0
    s_cbranch_scc0 Lp2c_22
    s_waitcnt vmcnt(0)
    s_mov_b32 s56, 0
Lp2l_23:
    v_cmp_le_u32 vcc, 32, v29
    s_and_b32 s53, vcc_lo, 0xff
    s_cmp_eq_u32 s53, 0xff
    s_cbranch_scc1 Lp2c_22
    s_mov_b64 s[54:55], exec
    s_mov_b64 exec, 0xff
    global_load_dword v29, v28, s[48:49] sc1
    s_mov_b64 exec, s[54:55]
    s_waitcnt vmcnt(0)
    s_add_u32 s56, s56, 1
    s_cmp_lt_u32 s56, 0x40000
    s_cbranch_scc1 Lp2l_23
Lp2c_22:
    s_waitcnt lgkmcnt(0)
    s_barrier
    global_load_dword v254, v196, s[48:49]
    s_add_u32 m0, s28, 0
    s_nop 0
    buffer_load_dwordx4 v224, s[20:23], s24 offen offset:0  lds
    buffer_load_dwordx4 v225, s[20:23], s24 offen offset:1024  lds
    s_add_u32 m0, s28, 2048
    s_nop 0
    buffer_load_dwordx4 v226, s[20:23], s24 offen offset:0  lds
    buffer_load_dwordx4 v227, s[20:23], s24 offen offset:1024  lds
    s_add_u32 m0, s28, 4096
    s_nop 0
    buffer_load_dwordx4 v228, s[20:23], s24 offen offset:0  lds
    buffer_load_dwordx4 v229, s[20:23], s24 offen offset:1024  lds
    global_load_dwordx4 a[0:3], v192, s[48:49] offset:0
    global_load_dwordx4 a[4:7], v193, s[48:49] offset:0
    global_load_dwordx4 a[16:19], v192, s[48:49] offset:1024
    global_load_dwordx4 a[20:23], v193, s[48:49] offset:1024
    global_load_dwordx4 a[32:35], v192, s[48:49] offset:2048
    v_add_u32 v192, 3072, v192
    global_load_dwordx4 a[36:39], v193, s[48:49] offset:2048
    v_add_u32 v193, 3072, v193
    s_mov_b32 s59, 0x3f803f80
    ds_read_b32 v208, v239 offset:0
    ds_read_b32 v209, v239 offset:64
    ds_read_b32 v210, v239 offset:128
    ds_read_b32 v211, v239 offset:192
    ds_read_b32 v212, v239 offset:256
    ds_read_b32 v213, v239 offset:320
    ds_read_b32 v214, v239 offset:384
    ds_read_b128 v[156:159], v248 offset:0
    ds_read_b128 v[160:163], v248 offset:64
    ds_read_b128 v[164:167], v248 offset:128
    ds_read_b128 v[168:171], v248 offset:192
    ds_read_b128 v[172:175], v248 offset:256
    ds_read_b128 v[176:179], v248 offset:320
    ds_read_b128 v[180:183], v248 offset:384
    s_waitcnt lgkmcnt(7)
    v_mfma_f32_16x16x4_f32 v[128:131], v208, v249, 0
    v_mfma_f32_16x16x4_f32 v[132:135], v209, v249, 0
    v_mfma_f32_16x16x4_f32 v[136:139], v210, v249, 0
    v_mfma_f32_16x16x4_f32 v[140:143], v211, v249, 0
    v_mfma_f32_16x16x4_f32 v[144:147], v212, v249, 0
    v_mfma_f32_16x16x4_f32 v[148:151], v213, v249, 0
    v_mfma_f32_16x16x4_f32 v[152:155], v214, v249, 0
    ds_read_b128 v[32:35], v188 offset:0
    ds_read_b128 v[36:39], v188 offset:1024
    ds_read_b128 v[40:43], v188 offset:2048
    ds_read_b128 v[44:47], v188 offset:3072
    s_waitcnt vmcnt(10)
    ds_read_b64_tr_b16 v[16:17], v186 offset:0
    ds_read_b64_tr_b16 v[18:19], v186 offset:1024
    ds_read_b64_tr_b16 v[20:21], v187 offset:0
    ds_read_b64_tr_b16 v[22:23], v187 offset:1024
    ds_read_b128 v[48:51], v188 offset:4096
    ds_read_b128 v[52:55], v188 offset:5120
    ds_read_b128 v[56:59], v188 offset:6144
    s_waitcnt lgkmcnt(3)
    v_mfma_f32_16x16x32_bf16 v[64:67], v[32:35], v[16:19], 0
    s_waitcnt vmcnt(8)
    ds_read_b64_tr_b16 v[24:25], v186 offset:2048
    v_mfma_f32_16x16x32_bf16 v[68:71], v[32:35], v[20:23], 0
    ds_read_b128 v[32:35], v188 offset:7168
    v_mfma_f32_16x16x32_bf16 v[72:75], v[36:39], v[16:19], 0
    ds_read_b64_tr_b16 v[26:27], v186 offset:3072
    v_mfma_f32_16x16x32_bf16 v[76:79], v[36:39], v[20:23], 0
    ds_read_b128 v[36:39], v188 offset:8192
    v_mfma_f32_16x16x32_bf16 v[80:83], v[40:43], v[16:19], 0
    ds_read_b64_tr_b16 v[28:29], v187 offset:2048
    s_waitcnt lgkmcnt(5)
    v_mfma_f32_16x16x32_bf16 v[84:87], v[40:43], v[20:23], 0
    ds_read_b128 v[40:43], v188 offset:9216
    v_mfma_f32_16x16x32_bf16 v[88:91], v[44:47], v[16:19], 0
    ds_read_b64_tr_b16 v[30:31], v187 offset:3072
    s_add_u32 m0, s28, 6144
    v_mfma_f32_16x16x32_bf16 v[92:95], v[44:47], v[20:23], 0
    ds_read_b128 v[44:47], v188 offset:10240
    v_mfma_f32_16x16x32_bf16 v[96:99], v[48:51], v[16:19], 0
    buffer_load_dwordx4 v230, s[20:23], s24 offen offset:0  lds
    v_mfma_f32_16x16x32_bf16 v[100:103], v[48:51], v[20:23], 0
    ds_read_b128 v[48:51], v188 offset:11264
    v_mfma_f32_16x16x32_bf16 v[104:107], v[52:55], v[16:19], 0
    buffer_load_dwordx4 v231, s[20:23], s24 offen offset:1024  lds
    v_mfma_f32_16x16x32_bf16 v[108:111], v[52:55], v[20:23], 0
    ds_read_b128 v[52:55], v188 offset:12288
    v_mfma_f32_16x16x32_bf16 v[112:115], v[56:59], v[16:19], 0
    s_add_u32 m0, s28, 8192
    s_nop 0
    buffer_load_dwordx4 v224, s[20:23], s25 offen offset:0  lds
    buffer_load_dwordx4 v225, s[20:23], s25 offen offset:1024  lds
    s_waitcnt lgkmcnt(2)
    v_mfma_f32_16x16x32_bf16 v[116:119], v[56:59], v[20:23], 0
    ds_read_b128 v[56:59], v188 offset:13312
    v_dot2c_f32_bf16 v60, s59, v16
    v_dot2c_f32_bf16 v61, v16, v16
    v_dot2c_f32_bf16 v62, s59, v20
    v_dot2c_f32_bf16 v63, v20, v20
    v_dot2c_f32_bf16 v60, s59, v17
    v_dot2c_f32_bf16 v61, v17, v17
    v_dot2c_f32_bf16 v62, s59, v21
    v_dot2c_f32_bf16 v63, v21, v21
    v_dot2c_f32_bf16 v60, s59, v18
    v_dot2c_f32_bf16 v61, v18, v18
    v_dot2c_f32_bf16 v62, s59, v22
    v_dot2c_f32_bf16 v63, v22, v22
    v_dot2c_f32_bf16 v60, s59, v19
    v_dot2c_f32_bf16 v61, v19, v19
    v_dot2c_f32_bf16 v62, s59, v23
    v_dot2c_f32_bf16 v63, v23, v23
    v_mfma_f32_16x16x32_bf16 v[64:67], v[32:35], v[24:27], v[64:67]
    s_waitcnt vmcnt(10)
    ds_read_b64_tr_b16 v[16:17], v186 offset:4096
    v_mfma_f32_16x16x32_bf16 v[68:71], v[32:35], v[28:31], v[68:71]
    ds_read_b128 v[32:35], v188 offset:14336
    v_mfma_f32_16x16x32_bf16 v[72:75], v[36:39], v[24:27], v[72:75]
    ds_read_b64_tr_b16 v[18:19], v186 offset:5120
    v_mfma_f32_16x16x32_bf16 v[76:79], v[36:39], v[28:31], v[76:79]
    ds_read_b128 v[36:39], v188 offset:15360
    v_mfma_f32_16x16x32_bf16 v[80:83], v[40:43], v[24:27], v[80:83]
    ds_read_b64_tr_b16 v[20:21], v187 offset:4096
    s_waitcnt lgkmcnt(5)
    v_mfma_f32_16x16x32_bf16 v[84:87], v[40:43], v[28:31], v[84:87]
    ds_read_b128 v[40:43], v188 offset:16384
    v_mfma_f32_16x16x32_bf16 v[88:91], v[44:47], v[24:27], v[88:91]
    ds_read_b64_tr_b16 v[22:23], v187 offset:5120
    s_add_u32 m0, s28, 0
    v_mfma_f32_16x16x32_bf16 v[92:95], v[44:47], v[28:31], v[92:95]
    ds_read_b128 v[44:47], v188 offset:17408
    v_mfma_f32_16x16x32_bf16 v[96:99], v[48:51], v[24:27], v[96:99]
    buffer_load_dwordx4 v226, s[20:23], s25 offen offset:0  lds
    v_mfma_f32_16x16x32_bf16 v[100:103], v[48:51], v[28:31], v[100:103]
    ds_read_b128 v[48:51], v188 offset:18432
    v_mfma_f32_16x16x32_bf16 v[104:107], v[52:55], v[24:27], v[104:107]
    buffer_load_dwordx4 v227, s[20:23], s25 offen offset:1024  lds
    v_mfma_f32_16x16x32_bf16 v[108:111], v[52:55], v[28:31], v[108:111]
    ds_read_b128 v[52:55], v188 offset:19456
    v_mfma_f32_16x16x32_bf16 v[112:115], v[56:59], v[24:27], v[112:115]
    s_add_u32 m0, s28, 2048
    s_nop 0
    buffer_load_dwordx4 v228, s[20:23], s25 offen offset:0  lds
    buffer_load_dwordx4 v229, s[20:23], s25 offen offset:1024  lds
    s_waitcnt lgkmcnt(2)
    v_mfma_f32_16x16x32_bf16 v[116:119], v[56:59], v[28:31], v[116:119]
    ds_read_b128 v[56:59], v188 offset:20480
    v_dot2c_f32_bf16 v60, s59, v24
    v_dot2c_f32_bf16 v61, v24, v24
    v_dot2c_f32_bf16 v62, s59, v28
    v_dot2c_f32_bf16 v63, v28, v28
    v_dot2c_f32_bf16 v60, s59, v25
    v_dot2c_f32_bf16 v61, v25, v25
    v_dot2c_f32_bf16 v62, s59, v29
    v_dot2c_f32_bf16 v63, v29, v29
    v_dot2c_f32_bf16 v60, s59, v26
    v_dot2c_f32_bf16 v61, v26, v26
    v_dot2c_f32_bf16 v62, s59, v30
    v_dot2c_f32_bf16 v63, v30, v30
    v_dot2c_f32_bf16 v60, s59, v27
    v_dot2c_f32_bf16 v61, v27, v27
    v_dot2c_f32_bf16 v62, s59, v31
    v_dot2c_f32_bf16 v63, v31, v31
    v_mfma_f32_16x16x32_bf16 v[64:67], v[32:35], v[16:19], v[64:67]
    s_waitcnt vmcnt(6)
    ds_read_b64_tr_b16 v[24:25], v186 offset:6144
    v_mfma_f32_16x16x32_bf16 v[68:71], v[32:35], v[20:23], v[68:71]
    ds_read_b128 v[32:35], v188 offset:21504
    v_mfma_f32_16x16x32_bf16 v[72:75], v[36:39], v[16:19], v[72:75]
    ds_read_b64_tr_b16 v[26:27], v186 offset:7168
    global_load_dwordx4 a[48:51], v192, s[48:49] offset:0
    v_mfma_f32_16x16x32_bf16 v[76:79], v[36:39], v[20:23], v[76:79]
    ds_read_b128 v[36:39], v188 offset:22528
    v_mfma_f32_16x16x32_bf16 v[80:83], v[40:43], v[16:19], v[80:83]
    ds_read_b64_tr_b16 v[28:29], v187 offset:6144
    s_waitcnt lgkmcnt(5)
    v_mfma_f32_16x16x32_bf16 v[84:87], v[40:43], v[20:23], v[84:87]
    ds_read_b128 v[40:43], v188 offset:23552
    v_mfma_f32_16x16x32_bf16 v[88:91], v[44:47], v[16:19], v[88:91]
    ds_read_b64_tr_b16 v[30:31], v187 offset:7168
    s_add_u32 m0, s28, 4096
    v_mfma_f32_16x16x32_bf16 v[92:95], v[44:47], v[20:23], v[92:95]
    ds_read_b128 v[44:47], v188 offset:24576
    v_mfma_f32_16x16x32_bf16 v[96:99], v[48:51], v[16:19], v[96:99]
    buffer_load_dwordx4 v230, s[20:23], s25 offen offset:0  lds
    v_mfma_f32_16x16x32_bf16 v[100:103], v[48:51], v[20:23], v[100:103]
    ds_read_b128 v[48:51], v188 offset:25600
    v_mfma_f32_16x16x32_bf16 v[104:107], v[52:55], v[16:19], v[104:107]
    buffer_load_dwordx4 v231, s[20:23], s25 offen offset:1024  lds
    v_mfma_f32_16x16x32_bf16 v[108:111], v[52:55], v[20:23], v[108:111]
    ds_read_b128 v[52:55], v188 offset:26624
    v_mfma_f32_16x16x32_bf16 v[112:115], v[56:59], v[16:19], v[112:115]
    global_load_dwordx4 a[52:55], v193, s[48:49] offset:0
    s_waitcnt lgkmcnt(2)
    v_mfma_f32_16x16x32_bf16 v[116:119], v[56:59], v[20:23], v[116:119]
    ds_read_b128 v[56:59], v188 offset:27648
    v_dot2c_f32_bf16 v60, s59, v16
    v_dot2c_f32_bf16 v61, v16, v16
    v_dot2c_f32_bf16 v62, s59, v20
    v_dot2c_f32_bf16 v63, v20, v20
    v_dot2c_f32_bf16 v60, s59, v17
    v_dot2c_f32_bf16 v61, v17, v17
    v_dot2c_f32_bf16 v62, s59, v21
    v_dot2c_f32_bf16 v63, v21, v21
    v_dot2c_f32_bf16 v60, s59, v18
    v_dot2c_f32_bf16 v61, v18, v18
    v_dot2c_f32_bf16 v62, s59, v22
    v_dot2c_f32_bf16 v63, v22, v22
    v_dot2c_f32_bf16 v60, s59, v19
    v_dot2c_f32_bf16 v61, v19, v19
    v_dot2c_f32_bf16 v62, s59, v23
    v_dot2c_f32_bf16 v63, v23, v23
    v_mfma_f32_16x16x32_bf16 v[64:67], v[32:35], v[24:27], v[64:67]
    s_waitcnt vmcnt(8)
    ds_read_b64_tr_b16 v[16:17], v186 offset:8192
    v_mfma_f32_16x16x32_bf16 v[68:71], v[32:35], v[28:31], v[68:71]
    ds_read_b128 v[32:35], v189 offset:0
    v_mfma_f32_16x16x32_bf16 v[72:75], v[36:39], v[24:27], v[72:75]
    ds_read_b64_tr_b16 v[18:19], v186 offset:9216
    global_load_dwordx4 a[64:67], v192, s[48:49] offset:1024
    v_mfma_f32_16x16x32_bf16 v[76:79], v[36:39], v[28:31], v[76:79]
    ds_read_b128 v[36:39], v189 offset:1024
    v_mfma_f32_16x16x32_bf16 v[80:83], v[40:43], v[24:27], v[80:83]
    ds_read_b64_tr_b16 v[20:21], v187 offset:8192
    s_waitcnt lgkmcnt(5)
    v_mfma_f32_16x16x32_bf16 v[84:87], v[40:43], v[28:31], v[84:87]
    ds_read_b128 v[40:43], v189 offset:2048
    v_mfma_f32_16x16x32_bf16 v[88:91], v[44:47], v[24:27], v[88:91]
    ds_read_b64_tr_b16 v[22:23], v187 offset:9216
    s_add_u32 m0, s28, 6144
    v_mfma_f32_16x16x32_bf16 v[92:95], v[44:47], v[28:31], v[92:95]
    ds_read_b128 v[44:47], v189 offset:3072
    v_mfma_f32_16x16x32_bf16 v[96:99], v[48:51], v[24:27], v[96:99]
    buffer_load_dwordx4 v224, s[20:23], s26 offen offset:0  lds
    v_mfma_f32_16x16x32_bf16 v[100:103], v[48:51], v[28:31], v[100:103]
    ds_read_b128 v[48:51], v189 offset:4096
    v_mfma_f32_16x16x32_bf16 v[104:107], v[52:55], v[24:27], v[104:107]
    buffer_load_dwordx4 v225, s[20:23], s26 offen offset:1024  lds
    v_mfma_f32_16x16x32_bf16 v[108:111], v[52:55], v[28:31], v[108:111]
    ds_read_b128 v[52:55], v189 offset:5120
    v_mfma_f32_16x16x32_bf16 v[112:115], v[56:59], v[24:27], v[112:115]
    global_load_dwordx4 a[68:71], v193, s[48:49] offset:1024
    s_waitcnt lgkmcnt(2)
    v_mfma_f32_16x16x32_bf16 v[116:119], v[56:59], v[28:31], v[116:119]
    ds_read_b128 v[56:59], v189 offset:6144
    v_dot2c_f32_bf16 v60, s59, v24
    v_dot2c_f32_bf16 v61, v24, v24
    v_dot2c_f32_bf16 v62, s59, v28
    v_dot2c_f32_bf16 v63, v28, v28
    v_dot2c_f32_bf16 v60, s59, v25
    v_dot2c_f32_bf16 v61, v25, v25
    v_dot2c_f32_bf16 v62, s59, v29
    v_dot2c_f32_bf16 v63, v29, v29
    v_dot2c_f32_bf16 v60, s59, v26
    v_dot2c_f32_bf16 v61, v26, v26
    v_dot2c_f32_bf16 v62, s59, v30
    v_dot2c_f32_bf16 v63, v30, v30
    v_dot2c_f32_bf16 v60, s59, v27
    v_dot2c_f32_bf16 v61, v27, v27
    v_dot2c_f32_bf16 v62, s59, v31
    v_dot2c_f32_bf16 v63, v31, v31
    s_and_b32 s53, s52, 3
    s_cmp_eq_u32 s53, 0
    s_cbranch_scc0 Lstp_24
    s_nop 2
    v_mov_b32 v208, v60
    v_mov_b32 v209, v61
    v_mov_b32 v210, v62
    v_mov_b32 v211, v63
    s_nop 1
    v_permlane16_swap_b32 v208, v60
    v_permlane16_swap_b32 v209, v61
    v_permlane16_swap_b32 v210, v62
    v_permlane16_swap_b32 v211, v63
    s_nop 1
    v_add_f32 v60, v60, v208
    v_add_f32 v61, v61, v209
    v_add_f32 v62, v62, v210
    v_add_f32 v63, v63, v211
    v_mov_b32 v208, v60
    v_mov_b32 v209, v61
    v_mov_b32 v210, v62
    v_mov_b32 v211, v63
    s_nop 1
    v_permlane32_swap_b32 v208, v60
    v_permlane32_swap_b32 v209, v61
    v_permlane32_swap_b32 v210, v62
    v_permlane32_swap_b32 v211, v63
    s_nop 1
    v_add_f32 v60, v60, v208
    v_add_f32 v61, v61, v209
    v_add_f32 v62, v62, v210
    v_add_f32 v63, v63, v211
    v_bfe_u32 v8, v2, 4, 1
    v_cmp_eq_u32 vcc, 1, v8
    s_nop 1
    v_cndmask_b32 v208, v60, v62, vcc
    v_cndmask_b32 v209, v61, v63, vcc
    v_add_f32 v209, 1.0, v209
    v_lshlrev_b32 v8, 3, v2
    s_lshl_b32 s53, s51, 12
    s_lshl_b32 s54, s31, 10
    s_add_u32 s53, s53, s54
    s_lshl_b32 s54, s18, 8
    s_add_u32 s53, s53, s54
    s_add_u32 s53, s53, 2228224
    v_add_u32 v8, s53, v8
    s_mov_b64 s[56:57], exec
    s_mov_b32 exec_hi, 0
    global_store_dwordx2 v8, v[208:209], s[48:49] sc1
    s_mov_b64 exec, s[56:57]
Lstp_24:
    v_mfma_f32_16x16x32_bf16 v[64:67], v[32:35], v[16:19], v[64:67]
    s_waitcnt vmcnt(10)
    ds_read_b64_tr_b16 v[24:25], v186 offset:0
    v_mfma_f32_16x16x32_bf16 v[68:71], v[32:35], v[20:23], v[68:71]
    ds_read_b128 v[32:35], v189 offset:7168
    v_mfma_f32_16x16x32_bf16 v[72:75], v[36:39], v[16:19], v[72:75]
    ds_read_b64_tr_b16 v[26:27], v186 offset:1024
    v_mfma_f32_16x16x32_bf16 v[76:79], v[36:39], v[20:23], v[76:79]
    ds_read_b128 v[36:39], v189 offset:8192
    v_mfma_f32_16x16x32_bf16 v[80:83], v[40:43], v[16:19], v[80:83]
    ds_read_b64_tr_b16 v[28:29], v187 offset:0
    s_waitcnt lgkmcnt(5)
    v_mfma_f32_16x16x32_bf16 v[84:87], v[40:43], v[20:23], v[84:87]
    ds_read_b128 v[40:43], v189 offset:9216
    v_mfma_f32_16x16x32_bf16 v[88:91], v[44:47], v[16:19], v[88:91]
    ds_read_b64_tr_b16 v[30:31], v187 offset:1024
    s_add_u32 m0, s28, 8192
    v_mfma_f32_16x16x32_bf16 v[92:95], v[44:47], v[20:23], v[92:95]
    ds_read_b128 v[44:47], v189 offset:10240
    v_mfma_f32_16x16x32_bf16 v[96:99], v[48:51], v[16:19], v[96:99]
    buffer_load_dwordx4 v226, s[20:23], s26 offen offset:0  lds
    v_mfma_f32_16x16x32_bf16 v[100:103], v[48:51], v[20:23], v[100:103]
    ds_read_b128 v[48:51], v189 offset:11264
    v_mfma_f32_16x16x32_bf16 v[104:107], v[52:55], v[16:19], v[104:107]
    buffer_load_dwordx4 v227, s[20:23], s26 offen offset:1024  lds
    v_mfma_f32_16x16x32_bf16 v[108:111], v[52:55], v[20:23], v[108:111]
    ds_read_b128 v[52:55], v189 offset:12288
    v_mfma_f32_16x16x32_bf16 v[112:115], v[56:59], v[16:19], v[112:115]
    global_load_dwordx4 a[80:83], v192, s[48:49] offset:2048
    v_add_u32 v192, 3072, v192
    s_waitcnt lgkmcnt(2)
    v_mfma_f32_16x16x32_bf16 v[116:119], v[56:59], v[20:23], v[116:119]
    ds_read_b128 v[56:59], v189 offset:13312
    v_mfma_f32_16x16x32_bf16 v[64:67], v[32:35], v[24:27], v[64:67]
    s_waitcnt vmcnt(11)
    ds_read_b64_tr_b16 v[16:17], v186 offset:2048
    v_mfma_f32_16x16x32_bf16 v[68:71], v[32:35], v[28:31], v[68:71]
    ds_read_b128 v[32:35], v189 offset:14336
    v_mfma_f32_16x16x32_bf16 v[72:75], v[36:39], v[24:27], v[72:75]
    ds_read_b64_tr_b16 v[18:19], v186 offset:3072
    v_mfma_f32_16x16x32_bf16 v[76:79], v[36:39], v[28:31], v[76:79]
    ds_read_b128 v[36:39], v189 offset:15360
    v_mfma_f32_16x16x32_bf16 v[80:83], v[40:43], v[24:27], v[80:83]
    ds_read_b64_tr_b16 v[20:21], v187 offset:2048
    s_waitcnt lgkmcnt(5)
    v_mfma_f32_16x16x32_bf16 v[84:87], v[40:43], v[28:31], v[84:87]
    ds_read_b128 v[40:43], v189 offset:16384
    v_mfma_f32_16x16x32_bf16 v[88:91], v[44:47], v[24:27], v[88:91]
    ds_read_b64_tr_b16 v[22:23], v187 offset:3072
    s_add_u32 m0, s28, 0
    v_mfma_f32_16x16x32_bf16 v[92:95], v[44:47], v[28:31], v[92:95]
    ds_read_b128 v[44:47], v189 offset:17408
    v_mfma_f32_16x16x32_bf16 v[96:99], v[48:51], v[24:27], v[96:99]
    buffer_load_dwordx4 v228, s[20:23], s26 offen offset:0  lds
    v_mfma_f32_16x16x32_bf16 v[100:103], v[48:51], v[28:31], v[100:103]
    ds_read_b128 v[48:51], v189 offset:18432
    v_mfma_f32_16x16x32_bf16 v[104:107], v[52:55], v[24:27], v[104:107]
    buffer_load_dwordx4 v229, s[20:23], s26 offen offset:1024  lds
    v_mfma_f32_16x16x32_bf16 v[108:111], v[52:55], v[28:31], v[108:111]
    ds_read_b128 v[52:55], v189 offset:19456
    v_mfma_f32_16x16x32_bf16 v[112:115], v[56:59], v[24:27], v[112:115]
    global_load_dwordx4 a[84:87], v193, s[48:49] offset:2048
    v_add_u32 v193, 3072, v193
    s_waitcnt lgkmcnt(2)
    v_mfma_f32_16x16x32_bf16 v[116:119], v[56:59], v[28:31], v[116:119]
    ds_read_b128 v[56:59], v189 offset:20480
    v_mfma_f32_16x16x32_bf16 v[64:67], v[32:35], v[16:19], v[64:67]
    s_waitcnt vmcnt(11)
    ds_read_b64_tr_b16 v[24:25], v186 offset:4096
    v_mfma_f32_16x16x32_bf16 v[68:71], v[32:35], v[20:23], v[68:71]
    ds_read_b128 v[32:35], v189 offset:21504
    v_mfma_f32_16x16x32_bf16 v[72:75], v[36:39], v[16:19], v[72:75]
    ds_read_b64_tr_b16 v[26:27], v186 offset:5120
    v_mfma_f32_16x16x32_bf16 v[76:79], v[36:39], v[20:23], v[76:79]
    ds_read_b128 v[36:39], v189 offset:22528
    v_mfma_f32_16x16x32_bf16 v[80:83], v[40:43], v[16:19], v[80:83]
    ds_read_b64_tr_b16 v[28:29], v187 offset:4096
    s_waitcnt lgkmcnt(5)
    v_mfma_f32_16x16x32_bf16 v[84:87], v[40:43], v[20:23], v[84:87]
    ds_read_b128 v[40:43], v189 offset:23552
    v_mfma_f32_16x16x32_bf16 v[88:91], v[44:47], v[16:19], v[88:91]
    ds_read_b64_tr_b16 v[30:31], v187 offset:5120
    s_add_u32 m0, s28, 2048
    v_mfma_f32_16x16x32_bf16 v[92:95], v[44:47], v[20:23], v[92:95]
    ds_read_b128 v[44:47], v189 offset:24576
    v_mfma_f32_16x16x32_bf16 v[96:99], v[48:51], v[16:19], v[96:99]
    buffer_load_dwordx4 v230, s[20:23], s26 offen offset:0  lds
    v_mfma_f32_16x16x32_bf16 v[100:103], v[48:51], v[20:23], v[100:103]
    ds_read_b128 v[48:51], v189 offset:25600
    v_mfma_f32_16x16x32_bf16 v[104:107], v[52:55], v[16:19], v[104:107]
    buffer_load_dwordx4 v231, s[20:23], s26 offen offset:1024  lds
    v_mfma_f32_16x16x32_bf16 v[108:111], v[52:55], v[20:23], v[108:111]
    ds_read_b128 v[52:55], v189 offset:26624
    v_mfma_f32_16x16x32_bf16 v[112:115], v[56:59], v[16:19], v[112:115]
    global_load_dwordx4 a[96:99], v192, s[48:49] offset:0
    s_waitcnt lgkmcnt(2)
    v_mfma_f32_16x16x32_bf16 v[116:119], v[56:59], v[20:23], v[116:119]
    ds_read_b128 v[56:59], v189 offset:27648
    v_mfma_f32_16x16x32_bf16 v[64:67], v[32:35], v[24:27], v[64:67]
    s_waitcnt vmcnt(10)
    ds_read_b64_tr_b16 v[16:17], v186 offset:6144
    v_mfma_f32_16x16x32_bf16 v[68:71], v[32:35], v[28:31], v[68:71]
    ds_read_b128 v[32:35], v190 offset:0
    v_mfma_f32_16x16x32_bf16 v[72:75], v[36:39], v[24:27], v[72:75]
    ds_read_b64_tr_b16 v[18:19], v186 offset:7168
    v_mfma_f32_16x16x32_bf16 v[76:79], v[36:39], v[28:31], v[76:79]
    ds_read_b128 v[36:39], v190 offset:1024
    v_mfma_f32_16x16x32_bf16 v[80:83], v[40:43], v[24:27], v[80:83]
    ds_read_b64_tr_b16 v[20:21], v187 offset:6144
    s_waitcnt lgkmcnt(5)
    v_mfma_f32_16x16x32_bf16 v[84:87], v[40:43], v[28:31], v[84:87]
    ds_read_b128 v[40:43], v190 offset:2048
    v_mfma_f32_16x16x32_bf16 v[88:91], v[44:47], v[24:27], v[88:91]
    ds_read_b64_tr_b16 v[22:23], v187 offset:7168
    s_add_u32 m0, s28, 4096
    v_mfma_f32_16x16x32_bf16 v[92:95], v[44:47], v[28:31], v[92:95]
    ds_read_b128 v[44:47], v190 offset:3072
    v_mfma_f32_16x16x32_bf16 v[96:99], v[48:51], v[24:27], v[96:99]
    buffer_load_dwordx4 v224, s[20:23], s27 offen offset:0  lds
    v_mfma_f32_16x16x32_bf16 v[100:103], v[48:51], v[28:31], v[100:103]
    ds_read_b128 v[48:51], v190 offset:4096
    v_mfma_f32_16x16x32_bf16 v[104:107], v[52:55], v[24:27], v[104:107]
    buffer_load_dwordx4 v225, s[20:23], s27 offen offset:1024  lds
    v_mfma_f32_16x16x32_bf16 v[108:111], v[52:55], v[28:31], v[108:111]
    ds_read_b128 v[52:55], v190 offset:5120
    v_mfma_f32_16x16x32_bf16 v[112:115], v[56:59], v[24:27], v[112:115]
    global_load_dwordx4 a[100:103], v193, s[48:49] offset:0
    s_waitcnt lgkmcnt(2)
    v_mfma_f32_16x16x32_bf16 v[116:119], v[56:59], v[28:31], v[116:119]
    ds_read_b128 v[56:59], v190 offset:6144
    v_mfma_f32_16x16x32_bf16 v[64:67], v[32:35], v[16:19], v[64:67]
    s_waitcnt vmcnt(10)
    ds_read_b64_tr_b16 v[24:25], v186 offset:8192
    v_mfma_f32_16x16x32_bf16 v[68:71], v[32:35], v[20:23], v[68:71]
    ds_read_b128 v[32:35], v190 offset:7168
    v_mfma_f32_16x16x32_bf16 v[72:75], v[36:39], v[16:19], v[72:75]
    ds_read_b64_tr_b16 v[26:27], v186 offset:9216
    v_mfma_f32_16x16x32_bf16 v[76:79], v[36:39], v[20:23], v[76:79]
    ds_read_b128 v[36:39], v190 offset:8192
    v_mfma_f32_16x16x32_bf16 v[80:83], v[40:43], v[16:19], v[80:83]
    ds_read_b64_tr_b16 v[28:29], v187 offset:8192
    s_waitcnt lgkmcnt(5)
    v_mfma_f32_16x16x32_bf16 v[84:87], v[40:43], v[20:23], v[84:87]
    ds_read_b128 v[40:43], v190 offset:9216
    v_mfma_f32_16x16x32_bf16 v[88:91], v[44:47], v[16:19], v[88:91]
    ds_read_b64_tr_b16 v[30:31], v187 offset:9216
    s_add_u32 m0, s28, 6144
    v_mfma_f32_16x16x32_bf16 v[92:95], v[44:47], v[20:23], v[92:95]
    ds_read_b128 v[44:47], v190 offset:10240
    v_mfma_f32_16x16x32_bf16 v[96:99], v[48:51], v[16:19], v[96:99]
    buffer_load_dwordx4 v226, s[20:23], s27 offen offset:0  lds
    v_mfma_f32_16x16x32_bf16 v[100:103], v[48:51], v[20:23], v[100:103]
    ds_read_b128 v[48:51], v190 offset:11264
    v_mfma_f32_16x16x32_bf16 v[104:107], v[52:55], v[16:19], v[104:107]
    buffer_load_dwordx4 v227, s[20:23], s27 offen offset:1024  lds
    v_mfma_f32_16x16x32_bf16 v[108:111], v[52:55], v[20:23], v[108:111]
    ds_read_b128 v[52:55], v190 offset:12288
    v_mfma_f32_16x16x32_bf16 v[112:115], v[56:59], v[16:19], v[112:115]
    global_load_dwordx4 a[112:115], v192, s[48:49] offset:1024
    s_waitcnt lgkmcnt(2)
    v_mfma_f32_16x16x32_bf16 v[116:119], v[56:59], v[20:23], v[116:119]
    ds_read_b128 v[56:59], v190 offset:13312
    v_mfma_f32_16x16x32_bf16 v[64:67], v[32:35], v[24:27], v[64:67]
    s_waitcnt vmcnt(10)
    ds_read_b64_tr_b16 v[16:17], v186 offset:0
    v_mfma_f32_16x16x32_bf16 v[68:71], v[32:35], v[28:31], v[68:71]
    ds_read_b128 v[32:35], v190 offset:14336
    v_mfma_f32_16x16x32_bf16 v[72:75], v[36:39], v[24:27], v[72:75]
    ds_read_b64_tr_b16 v[18:19], v186 offset:1024
    v_mfma_f32_16x16x32_bf16 v[76:79], v[36:39], v[28:31], v[76:79]
    ds_read_b128 v[36:39], v190 offset:15360
    v_mfma_f32_16x16x32_bf16 v[80:83], v[40:43], v[24:27], v[80:83]
    ds_read_b64_tr_b16 v[20:21], v187 offset:0
    s_waitcnt lgkmcnt(5)
    v_mfma_f32_16x16x32_bf16 v[84:87], v[40:43], v[28:31], v[84:87]
    ds_read_b128 v[40:43], v190 offset:16384
    v_mfma_f32_16x16x32_bf16 v[88:91], v[44:47], v[24:27], v[88:91]
    ds_read_b64_tr_b16 v[22:23], v187 offset:1024
    s_add_u32 m0, s28, 8192
    v_mfma_f32_16x16x32_bf16 v[92:95], v[44:47], v[28:31], v[92:95]
    ds_read_b128 v[44:47], v190 offset:17408
    v_mfma_f32_16x16x32_bf16 v[96:99], v[48:51], v[24:27], v[96:99]
    buffer_load_dwordx4 v228, s[20:23], s27 offen offset:0  lds
    v_mfma_f32_16x16x32_bf16 v[100:103], v[48:51], v[28:31], v[100:103]
    ds_read_b128 v[48:51], v190 offset:18432
    v_mfma_f32_16x16x32_bf16 v[104:107], v[52:55], v[24:27], v[104:107]
    buffer_load_dwordx4 v229, s[20:23], s27 offen offset:1024  lds
    v_mfma_f32_16x16x32_bf16 v[108:111], v[52:55], v[28:31], v[108:111]
    ds_read_b128 v[52:55], v190 offset:19456
    v_mfma_f32_16x16x32_bf16 v[112:115], v[56:59], v[24:27], v[112:115]
    global_load_dwordx4 a[116:119], v193, s[48:49] offset:1024
    s_waitcnt lgkmcnt(2)
    v_mfma_f32_16x16x32_bf16 v[116:119], v[56:59], v[28:31], v[116:119]
    ds_read_b128 v[56:59], v190 offset:20480
    v_mfma_f32_16x16x32_bf16 v[64:67], v[32:35], v[16:19], v[64:67]
    s_waitcnt vmcnt(10)
    ds_read_b64_tr_b16 v[24:25], v186 offset:2048
    v_mfma_f32_16x16x32_bf16 v[68:71], v[32:35], v[20:23], v[68:71]
    ds_read_b128 v[32:35], v190 offset:21504
    v_mfma_f32_16x16x32_bf16 v[72:75], v[36:39], v[16:19], v[72:75]
    ds_read_b64_tr_b16 v[26:27], v186 offset:3072
    v_mfma_f32_16x16x32_bf16 v[76:79], v[36:39], v[20:23], v[76:79]
    ds_read_b128 v[36:39], v190 offset:22528
    v_mfma_f32_16x16x32_bf16 v[80:83], v[40:43], v[16:19], v[80:83]
    ds_read_b64_tr_b16 v[28:29], v187 offset:2048
    s_waitcnt lgkmcnt(5)
    v_mfma_f32_16x16x32_bf16 v[84:87], v[40:43], v[20:23], v[84:87]
    ds_read_b128 v[40:43], v190 offset:23552
    v_mfma_f32_16x16x32_bf16 v[88:91], v[44:47], v[16:19], v[88:91]
    ds_read_b64_tr_b16 v[30:31], v187 offset:3072
    s_add_u32 m0, s28, 0
    v_mfma_f32_16x16x32_bf16 v[92:95], v[44:47], v[20:23], v[92:95]
    ds_read_b128 v[44:47], v190 offset:24576
    v_mfma_f32_16x16x32_bf16 v[96:99], v[48:51], v[16:19], v[96:99]
    buffer_load_dwordx4 v230, s[20:23], s27 offen offset:0  lds
    v_mfma_f32_16x16x32_bf16 v[100:103], v[48:51], v[20:23], v[100:103]
    ds_read_b128 v[48:51], v190 offset:25600
    v_mfma_f32_16x16x32_bf16 v[104:107], v[52:55], v[16:19], v[104:107]
    buffer_load_dwordx4 v231, s[20:23], s27 offen offset:1024  lds
    v_mfma_f32_16x16x32_bf16 v[108:111], v[52:55], v[20:23], v[108:111]
    ds_read_b128 v[52:55], v190 offset:26624
    v_mfma_f32_16x16x32_bf16 v[112:115], v[56:59], v[16:19], v[112:115]
    global_load_dwordx4 a[128:131], v192, s[48:49] offset:2048
    v_add_u32 v192, 3072, v192
    s_waitcnt lgkmcnt(2)
    v_mfma_f32_16x16x32_bf16 v[116:119], v[56:59], v[20:23], v[116:119]
    ds_read_b128 v[56:59], v190 offset:27648
    global_load_dwordx2 v[60:61], v232, s[48:49] sc1
    global_load_dwordx2 v[62:63], v232, s[48:49] offset:128 sc1
    v_mfma_f32_16x16x32_bf16 v[64:67], v[32:35], v[24:27], v[64:67]
    s_waitcnt vmcnt(12)
    ds_read_b64_tr_b16 v[16:17], v186 offset:4096
    v_mfma_f32_16x16x32_bf16 v[68:71], v[32:35], v[28:31], v[68:71]
    ds_read_b128 v[32:35], v191 offset:0
    v_mfma_f32_16x16x32_bf16 v[72:75], v[36:39], v[24:27], v[72:75]
    ds_read_b64_tr_b16 v[18:19], v186 offset:5120
    v_mfma_f32_16x16x32_bf16 v[76:79], v[36:39], v[28:31], v[76:79]
    ds_read_b128 v[36:39], v191 offset:1024
    v_mfma_f32_16x16x32_bf16 v[80:83], v[40:43], v[24:27], v[80:83]
    ds_read_b64_tr_b16 v[20:21], v187 offset:4096
    s_waitcnt lgkmcnt(5)
    v_mfma_f32_16x16x32_bf16 v[84:87], v[40:43], v[28:31], v[84:87]
    ds_read_b128 v[40:43], v191 offset:2048
    v_mfma_f32_16x16x32_bf16 v[88:91], v[44:47], v[24:27], v[88:91]
    ds_read_b64_tr_b16 v[22:23], v187 offset:5120
    v_mfma_f32_16x16x32_bf16 v[92:95], v[44:47], v[28:31], v[92:95]
    ds_read_b128 v[44:47], v191 offset:3072
    v_mfma_f32_16x16x32_bf16 v[96:99], v[48:51], v[24:27], v[96:99]
    v_mfma_f32_16x16x32_bf16 v[100:103], v[48:51], v[28:31], v[100:103]
    ds_read_b128 v[48:51], v191 offset:4096
    v_mfma_f32_16x16x32_bf16 v[104:107], v[52:55], v[24:27], v[104:107]
    v_mfma_f32_16x16x32_bf16 v[108:111], v[52:55], v[28:31], v[108:111]
    ds_read_b128 v[52:55], v191 offset:5120
    v_mfma_f32_16x16x32_bf16 v[112:115], v[56:59], v[24:27], v[112:115]
    global_load_dwordx4 a[132:135], v193, s[48:49] offset:2048
    v_add_u32 v193, 3072, v193
    s_waitcnt lgkmcnt(2)
    v_mfma_f32_16x16x32_bf16 v[116:119], v[56:59], v[28:31], v[116:119]
    ds_read_b128 v[56:59], v191 offset:6144
    v_mfma_f32_16x16x32_bf16 v[64:67], v[32:35], v[16:19], v[64:67]
    s_waitcnt vmcnt(10)
    ds_read_b64_tr_b16 v[24:25], v186 offset:6144
    v_mfma_f32_16x16x32_bf16 v[68:71], v[32:35], v[20:23], v[68:71]
    ds_read_b128 v[32:35], v191 offset:7168
    v_mfma_f32_16x16x32_bf16 v[72:75], v[36:39], v[16:19], v[72:75]
    ds_read_b64_tr_b16 v[26:27], v186 offset:7168
    v_mfma_f32_16x16x32_bf16 v[76:79], v[36:39], v[20:23], v[76:79]
    ds_read_b128 v[36:39], v191 offset:8192
    v_mfma_f32_16x16x32_bf16 v[80:83], v[40:43], v[16:19], v[80:83]
    ds_read_b64_tr_b16 v[28:29], v187 offset:6144
    s_waitcnt lgkmcnt(5)
    v_mfma_f32_16x16x32_bf16 v[84:87], v[40:43], v[20:23], v[84:87]
    ds_read_b128 v[40:43], v191 offset:9216
    v_mfma_f32_16x16x32_bf16 v[88:91], v[44:47], v[16:19], v[88:91]
    ds_read_b64_tr_b16 v[30:31], v187 offset:7168
    v_mfma_f32_16x16x32_bf16 v[92:95], v[44:47], v[20:23], v[92:95]
    ds_read_b128 v[44:47], v191 offset:10240
    v_mfma_f32_16x16x32_bf16 v[96:99], v[48:51], v[16:19], v[96:99]
    v_mfma_f32_16x16x32_bf16 v[100:103], v[48:51], v[20:23], v[100:103]
    ds_read_b128 v[48:51], v191 offset:11264
    v_mfma_f32_16x16x32_bf16 v[104:107], v[52:55], v[16:19], v[104:107]
    v_mfma_f32_16x16x32_bf16 v[108:111], v[52:55], v[20:23], v[108:111]
    ds_read_b128 v[52:55], v191 offset:12288
    v_mfma_f32_16x16x32_bf16 v[112:115], v[56:59], v[16:19], v[112:115]
    global_load_dwordx4 a[144:147], v192, s[48:49] offset:0
    s_waitcnt lgkmcnt(2)
    v_mfma_f32_16x16x32_bf16 v[116:119], v[56:59], v[20:23], v[116:119]
    ds_read_b128 v[56:59], v191 offset:13312
    v_mfma_f32_16x16x32_bf16 v[64:67], v[32:35], v[24:27], v[64:67]
    s_waitcnt vmcnt(8)
    ds_read_b64_tr_b16 v[16:17], v186 offset:8192
    v_mfma_f32_16x16x32_bf16 v[68:71], v[32:35], v[28:31], v[68:71]
    ds_read_b128 v[32:35], v191 offset:14336
    v_mfma_f32_16x16x32_bf16 v[72:75], v[36:39], v[24:27], v[72:75]
    ds_read_b64_tr_b16 v[18:19], v186 offset:9216
    v_mfma_f32_16x16x32_bf16 v[76:79], v[36:39], v[28:31], v[76:79]
    ds_read_b128 v[36:39], v191 offset:15360
    v_mfma_f32_16x16x32_bf16 v[80:83], v[40:43], v[24:27], v[80:83]
    ds_read_b64_tr_b16 v[20:21], v187 offset:8192
    s_waitcnt lgkmcnt(5)
    v_mfma_f32_16x16x32_bf16 v[84:87], v[40:43], v[28:31], v[84:87]
    ds_read_b128 v[40:43], v191 offset:16384
    v_mfma_f32_16x16x32_bf16 v[88:91], v[44:47], v[24:27], v[88:91]
    ds_read_b64_tr_b16 v[22:23], v187 offset:9216
    v_mfma_f32_16x16x32_bf16 v[92:95], v[44:47], v[28:31], v[92:95]
    ds_read_b128 v[44:47], v191 offset:17408
    v_mfma_f32_16x16x32_bf16 v[96:99], v[48:51], v[24:27], v[96:99]
    v_mfma_f32_16x16x32_bf16 v[100:103], v[48:51], v[28:31], v[100:103]
    ds_read_b128 v[48:51], v191 offset:18432
    v_mfma_f32_16x16x32_bf16 v[104:107], v[52:55], v[24:27], v[104:107]
    v_mfma_f32_16x16x32_bf16 v[108:111], v[52:55], v[28:31], v[108:111]
    ds_read_b128 v[52:55], v191 offset:19456
    v_mfma_f32_16x16x32_bf16 v[112:115], v[56:59], v[24:27], v[112:115]
    global_load_dwordx4 a[148:151], v193, s[48:49] offset:0
    s_waitcnt lgkmcnt(2)
    v_mfma_f32_16x16x32_bf16 v[116:119], v[56:59], v[28:31], v[116:119]
    ds_read_b128 v[56:59], v191 offset:20480
    v_mfma_f32_16x16x32_bf16 v[64:67], v[32:35], v[16:19], v[64:67]
    s_waitcnt vmcnt(6)
    ds_read_b64_tr_b16 v[24:25], v186 offset:0
    v_mfma_f32_16x16x32_bf16 v[68:71], v[32:35], v[20:23], v[68:71]
    ds_read_b128 v[32:35], v191 offset:21504
    v_mfma_f32_16x16x32_bf16 v[72:75], v[36:39], v[16:19], v[72:75]
    ds_read_b64_tr_b16 v[26:27], v186 offset:1024
    v_mfma_f32_16x16x32_bf16 v[76:79], v[36:39], v[20:23], v[76:79]
    ds_read_b128 v[36:39], v191 offset:22528
    v_mfma_f32_16x16x32_bf16 v[80:83], v[40:43], v[16:19], v[80:83]
    ds_read_b64_tr_b16 v[28:29], v187 offset:0
    s_waitcnt lgkmcnt(5)
    v_mfma_f32_16x16x32_bf16 v[84:87], v[40:43], v[20:23], v[84:87]
    ds_read_b128 v[40:43], v191 offset:23552
    v_mfma_f32_16x16x32_bf16 v[88:91], v[44:47], v[16:19], v[88:91]
    ds_read_b64_tr_b16 v[30:31], v187 offset:1024
    v_mfma_f32_16x16x32_bf16 v[92:95], v[44:47], v[20:23], v[92:95]
    ds_read_b128 v[44:47], v191 offset:24576
    v_mfma_f32_16x16x32_bf16 v[96:99], v[48:51], v[16:19], v[96:99]
    v_mfma_f32_16x16x32_bf16 v[100:103], v[48:51], v[20:23], v[100:103]
    ds_read_b128 v[48:51], v191 offset:25600
    v_mfma_f32_16x16x32_bf16 v[104:107], v[52:55], v[16:19], v[104:107]
    v_mfma_f32_16x16x32_bf16 v[108:111], v[52:55], v[20:23], v[108:111]
    ds_read_b128 v[52:55], v191 offset:26624
    v_mfma_f32_16x16x32_bf16 v[112:115], v[56:59], v[16:19], v[112:115]
    global_load_dwordx4 a[160:163], v192, s[48:49] offset:1024
    s_waitcnt lgkmcnt(2)
    v_mfma_f32_16x16x32_bf16 v[116:119], v[56:59], v[20:23], v[116:119]
    ds_read_b128 v[56:59], v191 offset:27648
    s_waitcnt vmcnt(4)
    s_mov_b32 s54, 0
Lsp_25:
    v_min_f32 v9, v61, v63
    v_cmp_le_f32 vcc, 0.5, v9
    s_cmp_eq_u64 vcc, exec
    s_cbranch_scc1 Lspd_26
    global_load_dwordx2 v[60:61], v232, s[48:49] sc1
    global_load_dwordx2 v[62:63], v232, s[48:49] offset:128 sc1
    s_waitcnt vmcnt(0)
    s_add_u32 s54, s54, 1
    s_cmp_lt_u32 s54, 0x40000
    s_cbranch_scc1 Lsp_25
Lspd_26:
    v_add_f32 v61, -1.0, v61
    v_add_f32 v63, -1.0, v63
    v_mfma_f32_16x16x32_bf16 v[64:67], v[32:35], v[24:27], v[64:67]
    v_mov_b32 v12, v60
    v_mov_b32 v13, v61
    v_mov_b32 v14, v62
    v_mov_b32 v15, v63
    v_mfma_f32_16x16x32_bf16 v[68:71], v[32:35], v[28:31], v[68:71]
    v_permlane16_swap_b32 v12, v60
    v_permlane16_swap_b32 v13, v61
    v_permlane16_swap_b32 v14, v62
    v_permlane16_swap_b32 v15, v63
    v_mfma_f32_16x16x32_bf16 v[72:75], v[36:39], v[24:27], v[72:75]
    v_add_f32 v60, v60, v12
    v_add_f32 v61, v61, v13
    v_add_f32 v62, v62, v14
    v_add_f32 v63, v63, v15
    v_mfma_f32_16x16x32_bf16 v[76:79], v[36:39], v[28:31], v[76:79]
    v_mov_b32 v12, v60
    v_mov_b32 v13, v61
    v_mov_b32 v14, v62
    v_mov_b32 v15, v63
    v_mfma_f32_16x16x32_bf16 v[80:83], v[40:43], v[24:27], v[80:83]
    s_waitcnt lgkmcnt(0)
    v_permlane32_swap_b32 v12, v60
    v_permlane32_swap_b32 v13, v61
    v_permlane32_swap_b32 v14, v62
    v_permlane32_swap_b32 v15, v63
    v_mfma_f32_16x16x32_bf16 v[84:87], v[40:43], v[28:31], v[84:87]
    v_add_f32 v60, v60, v12
    v_add_f32 v61, v61, v13
    v_add_f32 v62, v62, v14
    v_add_f32 v63, v63, v15
    v_mfma_f32_16x16x32_bf16 v[88:91], v[44:47], v[24:27], v[88:91]
    v_mul_f32 v60, 0x3b000000, v60
    v_mul_f32 v62, 0x3b000000, v62
    v_mul_f32 v61, 0x3b000000, v61
    v_mul_f32 v63, 0x3b000000, v63
    v_mfma_f32_16x16x32_bf16 v[92:95], v[44:47], v[28:31], v[92:95]
    v_fma_f32 v61, -v60, v60, v61
    v_fma_f32 v63, -v62, v62, v63
    v_max_f32 v61, 0, v61
    v_max_f32 v63, 0, v63
    v_mfma_f32_16x16x32_bf16 v[96:99], v[48:51], v[24:27], v[96:99]
    v_cvt_pk_bf16_f32 v17, v60, v61
    v_cvt_pk_bf16_f32 v19, v62, v63
    v_and_b32 v16, 0xffff0000, v17
    v_and_b32 v18, 0xffff0000, v19
    v_mfma_f32_16x16x32_bf16 v[100:103], v[48:51], v[28:31], v[100:103]
    v_lshlrev_b32 v17, 16, v17
    v_lshlrev_b32 v19, 16, v19
    v_add_f32 v16, 0x3727c5ac, v16
    v_add_f32 v18, 0x3727c5ac, v18
    v_mfma_f32_16x16x32_bf16 v[104:107], v[52:55], v[24:27], v[104:107]
    v_cvt_pk_bf16_f32 v16, v16, v16
    v_cvt_pk_bf16_f32 v18, v18, v18
    v_lshlrev_b32 v16, 16, v16
    v_lshlrev_b32 v18, 16, v18
    v_mfma_f32_16x16x32_bf16 v[108:111], v[52:55], v[28:31], v[108:111]
    v_sqrt_f32 v16, v16
    v_sqrt_f32 v18, v18
    v_mfma_f32_16x16x32_bf16 v[112:115], v[56:59], v[24:27], v[112:115]
    global_load_dwordx4 a[164:167], v193, s[48:49] offset:1024
    v_cvt_pk_bf16_f32 v16, v16, v16
    v_cvt_pk_bf16_f32 v18, v18, v18
    v_lshlrev_b32 v16, 16, v16
    v_lshlrev_b32 v18, 16, v18
    v_mfma_f32_16x16x32_bf16 v[116:119], v[56:59], v[28:31], v[116:119]
    v_rcp_f32 v16, v16
    v_rcp_f32 v18, v18
    v_mul_f32 v17, v17, v16
    v_mul_f32 v19, v19, v18
    v_mov_b32 v20, 0xbdd2d3e8
    v_mov_b32 v21, 0xbdd2d3e8
    v_mov_b32 v22, 0xc0135761
    v_mov_b32 v23, 0xc0135761
    s_waitcnt lgkmcnt(0)
    v_mov_b32 v24, 1.0
    v_mov_b32 v25, 1.0
    s_mov_b32 s58, 0xffff0000
    s_mov_b32 m0, s28
    s_nop 0
    buffer_load_dwordx4 v237, s[20:23], s8 offen  lds
    s_add_u32 m0, m0, 1024
    s_nop 0
    buffer_load_dwordx4 v237, s[20:23], s9 offen  lds
    global_load_dwordx2 v[224:225], v238, s[42:43] offset:0
    global_load_dwordx2 v[226:227], v238, s[42:43] offset:32
    global_load_dwordx2 v[228:229], v7, s[42:43] offset:0
    global_load_dwordx2 v[230:231], v7, s[42:43] offset:32
    v_pk_fma_f32 v[208:209], v[128:129], v[16:17], v[156:157] op_sel:[0,1,0] op_sel_hi:[1,1,1] neg_lo:[1,0,0] neg_hi:[1,0,0]
    v_pk_fma_f32 v[212:213], v[130:131], v[16:17], v[158:159] op_sel:[0,1,0] op_sel_hi:[1,1,1] neg_lo:[1,0,0] neg_hi:[1,0,0]
    v_pk_fma_f32 v[216:217], v[128:129], v[18:19], v[156:157] op_sel:[0,1,0] op_sel_hi:[1,1,1] neg_lo:[1,0,0] neg_hi:[1,0,0]
    v_pk_fma_f32 v[220:221], v[130:131], v[18:19], v[158:159] op_sel:[0,1,0] op_sel_hi:[1,1,1] neg_lo:[1,0,0] neg_hi:[1,0,0]
    v_pk_fma_f32 v[64:65], v[64:65], v[16:17], v[208:209] op_sel:[0,0,0] op_sel_hi:[1,0,1]
    v_pk_fma_f32 v[66:67], v[66:67], v[16:17], v[212:213] op_sel:[0,0,0] op_sel_hi:[1,0,1]
    v_pk_fma_f32 v[68:69], v[68:69], v[18:19], v[216:217] op_sel:[0,0,0] op_sel_hi:[1,0,1]
    v_pk_fma_f32 v[70:71], v[70:71], v[18:19], v[220:221] op_sel:[0,0,0] op_sel_hi:[1,0,1]
    global_load_dwordx4 a[176:179], v192, s[48:49] offset:2048
    v_add_u32 v192, 3072, v192
    v_pk_mul_f32 v[208:209], v[64:65], v[64:65]
    v_pk_mul_f32 v[212:213], v[66:67], v[66:67]
    v_pk_mul_f32 v[216:217], v[68:69], v[68:69]
    v_pk_mul_f32 v[220:221], v[70:71], v[70:71]
    global_load_dwordx4 a[180:183], v193, s[48:49] offset:2048
    v_add_u32 v193, 3072, v193
    v_pk_fma_f32 v[208:209], v[208:209], v[20:21], v[22:23]
    v_pk_fma_f32 v[212:213], v[212:213], v[20:21], v[22:23]
    v_pk_fma_f32 v[216:217], v[216:217], v[20:21], v[22:23]
    v_pk_fma_f32 v[220:221], v[220:221], v[20:21], v[22:23]
    global_load_dwordx4 a[192:195], v192, s[48:49] offset:0
    v_pk_mul_f32 v[208:209], v[208:209], v[64:65]
    v_pk_mul_f32 v[212:213], v[212:213], v[66:67]
    v_pk_mul_f32 v[216:217], v[216:217], v[68:69]
    v_pk_mul_f32 v[220:221], v[220:221], v[70:71]
    v_exp_f32 v210, v208
    v_exp_f32 v211, v209
    v_exp_f32 v214, v212
    v_exp_f32 v215, v213
    v_exp_f32 v218, v216
    v_exp_f32 v219, v217
    v_exp_f32 v222, v220
    v_exp_f32 v223, v221
    global_load_dwordx4 a[196:199], v193, s[48:49] offset:0
    v_pk_add_f32 v[210:211], v[210:211], v[24:25]
    v_pk_add_f32 v[214:215], v[214:215], v[24:25]
    v_pk_add_f32 v[218:219], v[218:219], v[24:25]
    v_pk_add_f32 v[222:223], v[222:223], v[24:25]
    v_rcp_f32 v210, v210
    v_rcp_f32 v211, v211
    v_rcp_f32 v214, v214
    v_rcp_f32 v215, v215
    v_rcp_f32 v218, v218
    v_rcp_f32 v219, v219
    v_rcp_f32 v222, v222
    v_rcp_f32 v223, v223
    global_load_dwordx4 a[208:211], v192, s[48:49] offset:1024
    v_pk_mul_f32 v[64:65], v[64:65], v[210:211]
    v_pk_mul_f32 v[66:67], v[66:67], v[214:215]
    v_pk_mul_f32 v[68:69], v[68:69], v[218:219]
    v_pk_mul_f32 v[70:71], v[70:71], v[222:223]
    v_cvt_pk_bf16_f32 v240, v64, v65
    v_cvt_pk_bf16_f32 v241, v66, v67
    v_cvt_pk_bf16_f32 v244, v68, v69
    v_cvt_pk_bf16_f32 v245, v70, v71
    v_pk_fma_f32 v[208:209], v[132:133], v[16:17], v[160:161] op_sel:[0,1,0] op_sel_hi:[1,1,1] neg_lo:[1,0,0] neg_hi:[1,0,0]
    v_pk_fma_f32 v[212:213], v[134:135], v[16:17], v[162:163] op_sel:[0,1,0] op_sel_hi:[1,1,1] neg_lo:[1,0,0] neg_hi:[1,0,0]
    v_pk_fma_f32 v[216:217], v[132:133], v[18:19], v[160:161] op_sel:[0,1,0] op_sel_hi:[1,1,1] neg_lo:[1,0,0] neg_hi:[1,0,0]
    v_pk_fma_f32 v[220:221], v[134:135], v[18:19], v[162:163] op_sel:[0,1,0] op_sel_hi:[1,1,1] neg_lo:[1,0,0] neg_hi:[1,0,0]
    v_pk_fma_f32 v[72:73], v[72:73], v[16:17], v[208:209] op_sel:[0,0,0] op_sel_hi:[1,0,1]
    v_pk_fma_f32 v[74:75], v[74:75], v[16:17], v[212:213] op_sel:[0,0,0] op_sel_hi:[1,0,1]
    v_pk_fma_f32 v[76:77], v[76:77], v[18:19], v[216:217] op_sel:[0,0,0] op_sel_hi:[1,0,1]
    v_pk_fma_f32 v[78:79], v[78:79], v[18:19], v[220:221] op_sel:[0,0,0] op_sel_hi:[1,0,1]
    global_load_dwordx4 a[212:215], v193, s[48:49] offset:1024
    v_pk_mul_f32 v[208:209], v[72:73], v[72:73]
    v_pk_mul_f32 v[212:213], v[74:75], v[74:75]
    v_pk_mul_f32 v[216:217], v[76:77], v[76:77]
    v_pk_mul_f32 v[220:221], v[78:79], v[78:79]
    global_load_dwordx4 a[8:11], v194, s[48:49] offset:0
    v_pk_fma_f32 v[208:209], v[208:209], v[20:21], v[22:23]
    v_pk_fma_f32 v[212:213], v[212:213], v[20:21], v[22:23]
    v_pk_fma_f32 v[216:217], v[216:217], v[20:21], v[22:23]
    v_pk_fma_f32 v[220:221], v[220:221], v[20:21], v[22:23]
    global_load_dwordx4 a[12:15], v195, s[48:49] offset:0
    v_pk_mul_f32 v[208:209], v[208:209], v[72:73]
    v_pk_mul_f32 v[212:213], v[212:213], v[74:75]
    v_pk_mul_f32 v[216:217], v[216:217], v[76:77]
    v_pk_mul_f32 v[220:221], v[220:221], v[78:79]
    v_exp_f32 v210, v208
    v_exp_f32 v211, v209
    v_exp_f32 v214, v212
    v_exp_f32 v215, v213
    v_exp_f32 v218, v216
    v_exp_f32 v219, v217
    v_exp_f32 v222, v220
    v_exp_f32 v223, v221
    global_load_dwordx4 a[24:27], v194, s[48:49] offset:1024
    v_pk_add_f32 v[210:211], v[210:211], v[24:25]
    v_pk_add_f32 v[214:215], v[214:215], v[24:25]
    v_pk_add_f32 v[218:219], v[218:219], v[24:25]
    v_pk_add_f32 v[222:223], v[222:223], v[24:25]
    v_rcp_f32 v210, v210
    v_rcp_f32 v211, v211
    v_rcp_f32 v214, v214
    v_rcp_f32 v215, v215
    v_rcp_f32 v218, v218
    v_rcp_f32 v219, v219
    v_rcp_f32 v222, v222
    v_rcp_f32 v223, v223
    global_load_dwordx4 a[28:31], v195, s[48:49] offset:1024
    v_pk_mul_f32 v[72:73], v[72:73], v[210:211]
    v_pk_mul_f32 v[74:75], v[74:75], v[214:215]
    v_pk_mul_f32 v[76:77], v[76:77], v[218:219]
    v_pk_mul_f32 v[78:79], v[78:79], v[222:223]
    v_cvt_pk_bf16_f32 v242, v72, v73
    v_cvt_pk_bf16_f32 v243, v74, v75
    v_cvt_pk_bf16_f32 v246, v76, v77
    v_cvt_pk_bf16_f32 v247, v78, v79
    global_store_dwordx4 v233, v[240:243], s[48:49] offset:0 sc1
    global_store_dwordx4 v234, v[244:247], s[48:49] offset:0 sc1
    v_pk_fma_f32 v[208:209], v[136:137], v[16:17], v[164:165] op_sel:[0,1,0] op_sel_hi:[1,1,1] neg_lo:[1,0,0] neg_hi:[1,0,0]
    v_pk_fma_f32 v[212:213], v[138:139], v[16:17], v[166:167] op_sel:[0,1,0] op_sel_hi:[1,1,1] neg_lo:[1,0,0] neg_hi:[1,0,0]
    v_pk_fma_f32 v[216:217], v[136:137], v[18:19], v[164:165] op_sel:[0,1,0] op_sel_hi:[1,1,1] neg_lo:[1,0,0] neg_hi:[1,0,0]
    v_pk_fma_f32 v[220:221], v[138:139], v[18:19], v[166:167] op_sel:[0,1,0] op_sel_hi:[1,1,1] neg_lo:[1,0,0] neg_hi:[1,0,0]
    v_pk_fma_f32 v[80:81], v[80:81], v[16:17], v[208:209] op_sel:[0,0,0] op_sel_hi:[1,0,1]
    v_pk_fma_f32 v[82:83], v[82:83], v[16:17], v[212:213] op_sel:[0,0,0] op_sel_hi:[1,0,1]
    v_pk_fma_f32 v[84:85], v[84:85], v[18:19], v[216:217] op_sel:[0,0,0] op_sel_hi:[1,0,1]
    v_pk_fma_f32 v[86:87], v[86:87], v[18:19], v[220:221] op_sel:[0,0,0] op_sel_hi:[1,0,1]
    v_pk_mul_f32 v[208:209], v[80:81], v[80:81]
    v_pk_mul_f32 v[212:213], v[82:83], v[82:83]
    v_pk_mul_f32 v[216:217], v[84:85], v[84:85]
    v_pk_mul_f32 v[220:221], v[86:87], v[86:87]
    v_pk_fma_f32 v[208:209], v[208:209], v[20:21], v[22:23]
    v_pk_fma_f32 v[212:213], v[212:213], v[20:21], v[22:23]
    v_pk_fma_f32 v[216:217], v[216:217], v[20:21], v[22:23]
    v_pk_fma_f32 v[220:221], v[220:221], v[20:21], v[22:23]
    v_pk_mul_f32 v[208:209], v[208:209], v[80:81]
    v_pk_mul_f32 v[212:213], v[212:213], v[82:83]
    v_pk_mul_f32 v[216:217], v[216:217], v[84:85]
    v_pk_mul_f32 v[220:221], v[220:221], v[86:87]
    v_exp_f32 v210, v208
    v_exp_f32 v211, v209
    v_exp_f32 v214, v212
    v_exp_f32 v215, v213
    v_exp_f32 v218, v216
    v_exp_f32 v219, v217
    v_exp_f32 v222, v220
    v_exp_f32 v223, v221
    v_pk_add_f32 v[210:211], v[210:211], v[24:25]
    v_pk_add_f32 v[214:215], v[214:215], v[24:25]
    v_pk_add_f32 v[218:219], v[218:219], v[24:25]
    v_pk_add_f32 v[222:223], v[222:223], v[24:25]
    v_rcp_f32 v210, v210
    v_rcp_f32 v211, v211
    v_rcp_f32 v214, v214
    v_rcp_f32 v215, v215
    v_rcp_f32 v218, v218
    v_rcp_f32 v219, v219
    v_rcp_f32 v222, v222
    v_rcp_f32 v223, v223
    v_pk_mul_f32 v[80:81], v[80:81], v[210:211]
    v_pk_mul_f32 v[82:83], v[82:83], v[214:215]
    v_pk_mul_f32 v[84:85], v[84:85], v[218:219]
    v_pk_mul_f32 v[86:87], v[86:87], v[222:223]
    v_cvt_pk_bf16_f32 v240, v80, v81
    v_cvt_pk_bf16_f32 v241, v82, v83
    v_cvt_pk_bf16_f32 v244, v84, v85
    v_cvt_pk_bf16_f32 v245, v86, v87
    v_pk_fma_f32 v[208:209], v[140:141], v[16:17], v[168:169] op_sel:[0,1,0] op_sel_hi:[1,1,1] neg_lo:[1,0,0] neg_hi:[1,0,0]
    v_pk_fma_f32 v[212:213], v[142:143], v[16:17], v[170:171] op_sel:[0,1,0] op_sel_hi:[1,1,1] neg_lo:[1,0,0] neg_hi:[1,0,0]
    v_pk_fma_f32 v[216:217], v[140:141], v[18:19], v[168:169] op_sel:[0,1,0] op_sel_hi:[1,1,1] neg_lo:[1,0,0] neg_hi:[1,0,0]
    v_pk_fma_f32 v[220:221], v[142:143], v[18:19], v[170:171] op_sel:[0,1,0] op_sel_hi:[1,1,1] neg_lo:[1,0,0] neg_hi:[1,0,0]
    v_pk_fma_f32 v[88:89], v[88:89], v[16:17], v[208:209] op_sel:[0,0,0] op_sel_hi:[1,0,1]
    v_pk_fma_f32 v[90:91], v[90:91], v[16:17], v[212:213] op_sel:[0,0,0] op_sel_hi:[1,0,1]
    v_pk_fma_f32 v[92:93], v[92:93], v[18:19], v[216:217] op_sel:[0,0,0] op_sel_hi:[1,0,1]
    v_pk_fma_f32 v[94:95], v[94:95], v[18:19], v[220:221] op_sel:[0,0,0] op_sel_hi:[1,0,1]
    v_pk_mul_f32 v[208:209], v[88:89], v[88:89]
    v_pk_mul_f32 v[212:213], v[90:91], v[90:91]
    v_pk_mul_f32 v[216:217], v[92:93], v[92:93]
    v_pk_mul_f32 v[220:221], v[94:95], v[94:95]
    v_pk_fma_f32 v[208:209], v[208:209], v[20:21], v[22:23]
    v_pk_fma_f32 v[212:213], v[212:213], v[20:21], v[22:23]
    v_pk_fma_f32 v[216:217], v[216:217], v[20:21], v[22:23]
    v_pk_fma_f32 v[220:221], v[220:221], v[20:21], v[22:23]
    v_pk_mul_f32 v[208:209], v[208:209], v[88:89]
    v_pk_mul_f32 v[212:213], v[212:213], v[90:91]
    v_pk_mul_f32 v[216:217], v[216:217], v[92:93]
    v_pk_mul_f32 v[220:221], v[220:221], v[94:95]
    v_exp_f32 v210, v208
    v_exp_f32 v211, v209
    v_exp_f32 v214, v212
    v_exp_f32 v215, v213
    v_exp_f32 v218, v216
    v_exp_f32 v219, v217
    v_exp_f32 v222, v220
    v_exp_f32 v223, v221
    v_pk_add_f32 v[210:211], v[210:211], v[24:25]
    v_pk_add_f32 v[214:215], v[214:215], v[24:25]
    v_pk_add_f32 v[218:219], v[218:219], v[24:25]
    v_pk_add_f32 v[222:223], v[222:223], v[24:25]
    v_rcp_f32 v210, v210
    v_rcp_f32 v211, v211
    v_rcp_f32 v214, v214
    v_rcp_f32 v215, v215
    v_rcp_f32 v218, v218
    v_rcp_f32 v219, v219
    v_rcp_f32 v222, v222
    v_rcp_f32 v223, v223
    v_pk_mul_f32 v[88:89], v[88:89], v[210:211]
    v_pk_mul_f32 v[90:91], v[90:91], v[214:215]
    v_pk_mul_f32 v[92:93], v[92:93], v[218:219]
    v_pk_mul_f32 v[94:95], v[94:95], v[222:223]
    v_cvt_pk_bf16_f32 v242, v88, v89
    v_cvt_pk_bf16_f32 v243, v90, v91
    v_cvt_pk_bf16_f32 v246, v92, v93
    v_cvt_pk_bf16_f32 v247, v94, v95
    global_store_dwordx4 v233, v[240:243], s[48:49] offset:1024 sc1
    global_store_dwordx4 v234, v[244:247], s[48:49] offset:1024 sc1
    v_pk_fma_f32 v[208:209], v[144:145], v[16:17], v[172:173] op_sel:[0,1,0] op_sel_hi:[1,1,1] neg_lo:[1,0,0] neg_hi:[1,0,0]
    v_pk_fma_f32 v[212:213], v[146:147], v[16:17], v[174:175] op_sel:[0,1,0] op_sel_hi:[1,1,1] neg_lo:[1,0,0] neg_hi:[1,0,0]
    v_pk_fma_f32 v[216:217], v[144:145], v[18:19], v[172:173] op_sel:[0,1,0] op_sel_hi:[1,1,1] neg_lo:[1,0,0] neg_hi:[1,0,0]
    v_pk_fma_f32 v[220:221], v[146:147], v[18:19], v[174:175] op_sel:[0,1,0] op_sel_hi:[1,1,1] neg_lo:[1,0,0] neg_hi:[1,0,0]
    v_pk_fma_f32 v[96:97], v[96:97], v[16:17], v[208:209] op_sel:[0,0,0] op_sel_hi:[1,0,1]
    v_pk_fma_f32 v[98:99], v[98:99], v[16:17], v[212:213] op_sel:[0,0,0] op_sel_hi:[1,0,1]
    v_pk_fma_f32 v[100:101], v[100:101], v[18:19], v[216:217] op_sel:[0,0,0] op_sel_hi:[1,0,1]
    v_pk_fma_f32 v[102:103], v[102:103], v[18:19], v[220:221] op_sel:[0,0,0] op_sel_hi:[1,0,1]
    v_pk_mul_f32 v[208:209], v[96:97], v[96:97]
    v_pk_mul_f32 v[212:213], v[98:99], v[98:99]
    v_pk_mul_f32 v[216:217], v[100:101], v[100:101]
    v_pk_mul_f32 v[220:221], v[102:103], v[102:103]
    v_pk_fma_f32 v[208:209], v[208:209], v[20:21], v[22:23]
    v_pk_fma_f32 v[212:213], v[212:213], v[20:21], v[22:23]
    v_pk_fma_f32 v[216:217], v[216:217], v[20:21], v[22:23]
    v_pk_fma_f32 v[220:221], v[220:221], v[20:21], v[22:23]
    v_pk_mul_f32 v[208:209], v[208:209], v[96:97]
    v_pk_mul_f32 v[212:213], v[212:213], v[98:99]
    v_pk_mul_f32 v[216:217], v[216:217], v[100:101]
    v_pk_mul_f32 v[220:221], v[220:221], v[102:103]
    v_exp_f32 v210, v208
    v_exp_f32 v211, v209
    v_exp_f32 v214, v212
    v_exp_f32 v215, v213
    v_exp_f32 v218, v216
    v_exp_f32 v219, v217
    v_exp_f32 v222, v220
    v_exp_f32 v223, v221
    v_pk_add_f32 v[210:211], v[210:211], v[24:25]
    v_pk_add_f32 v[214:215], v[214:215], v[24:25]
    v_pk_add_f32 v[218:219], v[218:219], v[24:25]
    v_pk_add_f32 v[222:223], v[222:223], v[24:25]
    v_rcp_f32 v210, v210
    v_rcp_f32 v211, v211
    v_rcp_f32 v214, v214
    v_rcp_f32 v215, v215
    v_rcp_f32 v218, v218
    v_rcp_f32 v219, v219
    v_rcp_f32 v222, v222
    v_rcp_f32 v223, v223
    v_pk_mul_f32 v[96:97], v[96:97], v[210:211]
    v_pk_mul_f32 v[98:99], v[98:99], v[214:215]
    v_pk_mul_f32 v[100:101], v[100:101], v[218:219]
    v_pk_mul_f32 v[102:103], v[102:103], v[222:223]
    v_cvt_pk_bf16_f32 v240, v96, v97
    v_cvt_pk_bf16_f32 v241, v98, v99
    v_cvt_pk_bf16_f32 v244, v100, v101
    v_cvt_pk_bf16_f32 v245, v102, v103
    v_pk_fma_f32 v[208:209], v[148:149], v[16:17], v[176:177] op_sel:[0,1,0] op_sel_hi:[1,1,1] neg_lo:[1,0,0] neg_hi:[1,0,0]
    v_pk_fma_f32 v[212:213], v[150:151], v[16:17], v[178:179] op_sel:[0,1,0] op_sel_hi:[1,1,1] neg_lo:[1,0,0] neg_hi:[1,0,0]
    v_pk_fma_f32 v[216:217], v[148:149], v[18:19], v[176:177] op_sel:[0,1,0] op_sel_hi:[1,1,1] neg_lo:[1,0,0] neg_hi:[1,0,0]
    v_pk_fma_f32 v[220:221], v[150:151], v[18:19], v[178:179] op_sel:[0,1,0] op_sel_hi:[1,1,1] neg_lo:[1,0,0] neg_hi:[1,0,0]
    v_pk_fma_f32 v[104:105], v[104:105], v[16:17], v[208:209] op_sel:[0,0,0] op_sel_hi:[1,0,1]
    v_pk_fma_f32 v[106:107], v[106:107], v[16:17], v[212:213] op_sel:[0,0,0] op_sel_hi:[1,0,1]
    v_pk_fma_f32 v[108:109], v[108:109], v[18:19], v[216:217] op_sel:[0,0,0] op_sel_hi:[1,0,1]
    v_pk_fma_f32 v[110:111], v[110:111], v[18:19], v[220:221] op_sel:[0,0,0] op_sel_hi:[1,0,1]
    v_pk_mul_f32 v[208:209], v[104:105], v[104:105]
    v_pk_mul_f32 v[212:213], v[106:107], v[106:107]
    v_pk_mul_f32 v[216:217], v[108:109], v[108:109]
    v_pk_mul_f32 v[220:221], v[110:111], v[110:111]
    v_pk_fma_f32 v[208:209], v[208:209], v[20:21], v[22:23]
    v_pk_fma_f32 v[212:213], v[212:213], v[20:21], v[22:23]
    v_pk_fma_f32 v[216:217], v[216:217], v[20:21], v[22:23]
    v_pk_fma_f32 v[220:221], v[220:221], v[20:21], v[22:23]
    v_pk_mul_f32 v[208:209], v[208:209], v[104:105]
    v_pk_mul_f32 v[212:213], v[212:213], v[106:107]
    v_pk_mul_f32 v[216:217], v[216:217], v[108:109]
    v_pk_mul_f32 v[220:221], v[220:221], v[110:111]
    v_exp_f32 v210, v208
    v_exp_f32 v211, v209
    v_exp_f32 v214, v212
    v_exp_f32 v215, v213
    v_exp_f32 v218, v216
    v_exp_f32 v219, v217
    v_exp_f32 v222, v220
    v_exp_f32 v223, v221
    v_pk_add_f32 v[210:211], v[210:211], v[24:25]
    v_pk_add_f32 v[214:215], v[214:215], v[24:25]
    v_pk_add_f32 v[218:219], v[218:219], v[24:25]
    v_pk_add_f32 v[222:223], v[222:223], v[24:25]
    v_rcp_f32 v210, v210
    v_rcp_f32 v211, v211
    v_rcp_f32 v214, v214
    v_rcp_f32 v215, v215
    v_rcp_f32 v218, v218
    v_rcp_f32 v219, v219
    v_rcp_f32 v222, v222
    v_rcp_f32 v223, v223
    v_pk_mul_f32 v[104:105], v[104:105], v[210:211]
    v_pk_mul_f32 v[106:107], v[106:107], v[214:215]
    v_pk_mul_f32 v[108:109], v[108:109], v[218:219]
    v_pk_mul_f32 v[110:111], v[110:111], v[222:223]
    v_cvt_pk_bf16_f32 v242, v104, v105
    v_cvt_pk_bf16_f32 v243, v106, v107
    v_cvt_pk_bf16_f32 v246, v108, v109
    v_cvt_pk_bf16_f32 v247, v110, v111
    global_store_dwordx4 v233, v[240:243], s[48:49] offset:2048 sc1
    global_store_dwordx4 v234, v[244:247], s[48:49] offset:2048 sc1
    v_pk_fma_f32 v[208:209], v[152:153], v[16:17], v[180:181] op_sel:[0,1,0] op_sel_hi:[1,1,1] neg_lo:[1,0,0] neg_hi:[1,0,0]
    v_pk_fma_f32 v[212:213], v[154:155], v[16:17], v[182:183] op_sel:[0,1,0] op_sel_hi:[1,1,1] neg_lo:[1,0,0] neg_hi:[1,0,0]
    v_pk_fma_f32 v[216:217], v[152:153], v[18:19], v[180:181] op_sel:[0,1,0] op_sel_hi:[1,1,1] neg_lo:[1,0,0] neg_hi:[1,0,0]
    v_pk_fma_f32 v[220:221], v[154:155], v[18:19], v[182:183] op_sel:[0,1,0] op_sel_hi:[1,1,1] neg_lo:[1,0,0] neg_hi:[1,0,0]
    v_pk_fma_f32 v[112:113], v[112:113], v[16:17], v[208:209] op_sel:[0,0,0] op_sel_hi:[1,0,1]
    v_pk_fma_f32 v[114:115], v[114:115], v[16:17], v[212:213] op_sel:[0,0,0] op_sel_hi:[1,0,1]
    v_pk_fma_f32 v[116:117], v[116:117], v[18:19], v[216:217] op_sel:[0,0,0] op_sel_hi:[1,0,1]
    v_pk_fma_f32 v[118:119], v[118:119], v[18:19], v[220:221] op_sel:[0,0,0] op_sel_hi:[1,0,1]
    v_pk_mul_f32 v[208:209], v[112:113], v[112:113]
    v_pk_mul_f32 v[212:213], v[114:115], v[114:115]
    v_pk_mul_f32 v[216:217], v[116:117], v[116:117]
    v_pk_mul_f32 v[220:221], v[118:119], v[118:119]
    v_pk_fma_f32 v[208:209], v[208:209], v[20:21], v[22:23]
    v_pk_fma_f32 v[212:213], v[212:213], v[20:21], v[22:23]
    v_pk_fma_f32 v[216:217], v[216:217], v[20:21], v[22:23]
    v_pk_fma_f32 v[220:221], v[220:221], v[20:21], v[22:23]
    v_pk_mul_f32 v[208:209], v[208:209], v[112:113]
    v_pk_mul_f32 v[212:213], v[212:213], v[114:115]
    v_pk_mul_f32 v[216:217], v[216:217], v[116:117]
    v_pk_mul_f32 v[220:221], v[220:221], v[118:119]
    v_exp_f32 v210, v208
    v_exp_f32 v211, v209
    v_exp_f32 v214, v212
    v_exp_f32 v215, v213
    v_exp_f32 v218, v216
    v_exp_f32 v219, v217
    v_exp_f32 v222, v220
    v_exp_f32 v223, v221
    v_pk_add_f32 v[210:211], v[210:211], v[24:25]
    v_pk_add_f32 v[214:215], v[214:215], v[24:25]
    v_pk_add_f32 v[218:219], v[218:219], v[24:25]
    v_pk_add_f32 v[222:223], v[222:223], v[24:25]
    v_rcp_f32 v210, v210
    v_rcp_f32 v211, v211
    v_rcp_f32 v214, v214
    v_rcp_f32 v215, v215
    v_rcp_f32 v218, v218
    v_rcp_f32 v219, v219
    v_rcp_f32 v222, v222
    v_rcp_f32 v223, v223
    v_pk_mul_f32 v[112:113], v[112:113], v[210:211]
    v_pk_mul_f32 v[114:115], v[114:115], v[214:215]
    v_pk_mul_f32 v[116:117], v[116:117], v[218:219]
    v_pk_mul_f32 v[118:119], v[118:119], v[222:223]
    v_cvt_pk_bf16_f32 v240, v112, v113
    v_cvt_pk_bf16_f32 v241, v114, v115
    v_cvt_pk_bf16_f32 v244, v116, v117
    v_cvt_pk_bf16_f32 v245, v118, v119
    global_store_dwordx2 v235, v[240:241], s[48:49] sc1
    global_store_dwordx2 v236, v[244:245], s[48:49] sc1
    s_lshl_b32 s53, s30, 2
    s_mul_i32 s53, s53, 57344
    s_mul_i32 s54, s18, 14336
    s_add_u32 s53, s53, s54
    s_add_u32 s53, s53, 8388608
    v_lshrrev_b32 v3, 5, v2
    v_mul_u32_u24 v3, 3584, v3
    v_and_b32 v4, 31, v2
    v_lshl_add_u32 v3, v4, 4, v3
    s_add_u32 s54, s18, 0
    s_and_b32 s54, s54, 3
    s_mul_i32 s54, s54, 57344
    s_add_u32 s54, s54, s53
    v_add_u32 v8, s54, v6
    s_add_u32 s54, s54, 3072
    v_add_u32 v12, s54, v3
    s_add_u32 s54, s18, 1
    s_and_b32 s54, s54, 3
    s_mul_i32 s54, s54, 57344
    s_add_u32 s54, s54, s53
    v_add_u32 v9, s54, v6
    s_add_u32 s54, s54, 3072
    v_add_u32 v13, s54, v3
    s_add_u32 s54, s18, 2
    s_and_b32 s54, s54, 3
    s_mul_i32 s54, s54, 57344
    s_add_u32 s54, s54, s53
    v_add_u32 v10, s54, v6
    s_add_u32 s54, s54, 3072
    v_add_u32 v14, s54, v3
    s_add_u32 s54, s18, 3
    s_and_b32 s54, s54, 3
    s_mul_i32 s54, s54, 57344
    s_add_u32 s54, s54, s53
    v_add_u32 v11, s54, v6
    s_add_u32 s54, s54, 3072
    v_add_u32 v15, s54, v3
    s_lshl_b32 s56, s51, 10
    s_add_u32 s56, s56, 2195456
    v_min_u32 v26, 7, v2
    v_lshlrev_b32 v26, 7, v26
    v_add_u32 v26, s56, v26
    s_and_b32 s57, s52, 7
    s_lshl_b32 s57, s57, 7
    s_add_u32 s56, s56, s57
    v_mov_b32 v24, s56
    v_mov_b32 v25, 1
    global_load_dwordx4 a[40:43], v194, s[48:49] offset:2048
    v_add_u32 v194, 3072, v194
    global_load_dwordx4 a[44:47], v195, s[48:49] offset:2048
    v_add_u32 v195, 3072, v195
    global_load_dwordx4 a[56:59], v194, s[48:49] offset:0
    global_load_dwordx4 a[60:63], v195, s[48:49] offset:0
    global_load_dwordx4 a[72:75], v194, s[48:49] offset:1024
    global_load_dwordx4 a[76:79], v195, s[48:49] offset:1024
    global_load_dwordx4 a[88:91], v194, s[48:49] offset:2048
    v_add_u32 v194, 3072, v194
    global_load_dwordx4 a[92:95], v195, s[48:49] offset:2048
    v_add_u32 v195, 3072, v195
    s_waitcnt vmcnt(8)
    s_barrier
    s_cmp_eq_u32 s18, 0
    s_cbranch_scc0 Larr_27
    s_mov_b64 exec, 1
    global_atomic_add v24, v25, s[48:49] sc1
    s_mov_b64 exec, -1
Larr_27:
    global_load_dwordx4 a[104:107], v194, s[48:49] offset:0
    global_load_dwordx4 a[108:111], v195, s[48:49] offset:0
    global_load_dwordx4 a[120:123], v194, s[48:49] offset:1024
    global_load_dwordx4 a[124:127], v195, s[48:49] offset:1024
    global_load_dwordx4 a[136:139], v194, s[48:49] offset:2048
    v_add_u32 v194, 3072, v194
    global_load_dwordx4 a[140:143], v195, s[48:49] offset:2048
    v_add_u32 v195, 3072, v195
    global_load_dwordx4 a[152:155], v194, s[48:49] offset:0
    global_load_dwordx4 a[156:159], v195, s[48:49] offset:0
    global_load_dwordx4 a[168:171], v194, s[48:49] offset:1024
    global_load_dwordx4 a[172:175], v195, s[48:49] offset:1024
    global_load_dwordx4 a[184:187], v194, s[48:49] offset:2048
    v_add_u32 v194, 3072, v194
    global_load_dwordx4 a[188:191], v195, s[48:49] offset:2048
    v_add_u32 v195, 3072, v195
    global_load_dwordx4 a[200:203], v194, s[48:49] offset:0
    s_cmp_eq_u32 s18, 0
    s_cbranch_scc0 Lp3i_28
    s_mov_b64 exec, 0xff
    global_load_dword v4, v26, s[48:49] sc1
    s_mov_b64 exec, -1
Lp3i_28:
    global_load_dwordx4 a[204:207], v195, s[48:49] offset:0
    global_load_dwordx4 a[216:219], v194, s[48:49] offset:1024
    global_load_dwordx4 a[220:223], v195, s[48:49] offset:1024
    s_cmp_eq_u32 s18, 0
    s_cbranch_scc0 Lpol_29
    s_mov_b32 s56, 0
    s_mov_b64 exec, 0xff
    s_waitcnt vmcnt(3)
    v_cmp_le_u32 vcc, 2, v4
    s_cmp_eq_u64 vcc, exec
    s_cbranch_scc1 Lpold_31
Lpoll_30:
    global_load_dword v4, v26, s[48:49] sc1
    s_waitcnt vmcnt(0)
    v_cmp_le_u32 vcc, 2, v4
    s_cmp_eq_u64 vcc, exec
    s_cbranch_scc1 Lpold_31
    s_add_u32 s56, s56, 1
    s_cmp_lt_u32 s56, 0x40000
    s_cbranch_scc1 Lpoll_30
Lpold_31:
    s_mov_b64 exec, -1
Lpol_29:
    s_barrier
    global_load_dwordx4 v[32:35], v8, s[48:49] offset:0
    global_load_dwordx4 v[36:39], v9, s[48:49] offset:0
    global_load_dwordx4 v[40:43], v10, s[48:49] offset:0
    global_load_dwordx4 v[44:47], v11, s[48:49] offset:0
    global_load_dwordx4 v[48:51], v8, s[48:49] offset:1024
    global_load_dwordx4 v[52:55], v9, s[48:49] offset:1024
    global_load_dwordx4 v[56:59], v10, s[48:49] offset:1024
    global_load_dwordx4 v[60:63], v11, s[48:49] offset:1024
    global_load_dwordx4 v[64:67], v8, s[48:49] offset:2048
    v_add_u32 v8, 3584, v8
    global_load_dwordx4 v[68:71], v9, s[48:49] offset:2048
    v_add_u32 v9, 3584, v9
    global_load_dwordx4 v[72:75], v10, s[48:49] offset:2048
    v_add_u32 v10, 3584, v10
    global_load_dwordx4 v[76:79], v11, s[48:49] offset:2048
    v_add_u32 v11, 3584, v11
    v_lshrrev_b32 v24, 2, v2
    v_lshlrev_b32 v24, 7, v24
    v_and_b32 v25, 3, v2
    v_lshlrev_b32 v25, 3, v25
    s_lshl_b32 s54, s18, 5
    s_add_u32 s54, s54, 114688
    v_add3_u32 v24, v24, v25, s54
    ds_read_b64_tr_b16 v[160:161], v24 offset:0
    ds_read_b64_tr_b16 v[162:163], v24 offset:10240
    ds_read_b64_tr_b16 v[164:165], v24 offset:20480
    ds_read_b64_tr_b16 v[166:167], v24 offset:30720
    s_mov_b32 s58, 0xffff0000
    v_lshlrev_b32 v168, 16, v224
    v_and_b32 v169, s58, v224
    s_waitcnt lgkmcnt(0)
    v_lshlrev_b32 v176, 16, v160
    v_and_b32 v177, s58, v160
    v_pk_add_f32 v[176:177], v[176:177], v[168:169]
    v_lshlrev_b32 v170, 16, v225
    v_and_b32 v171, s58, v225
    v_lshlrev_b32 v178, 16, v161
    v_and_b32 v179, s58, v161
    v_pk_add_f32 v[178:179], v[178:179], v[170:171]
    v_lshlrev_b32 v168, 16, v226
    v_and_b32 v169, s58, v226
    v_lshlrev_b32 v180, 16, v162
    v_and_b32 v181, s58, v162
    v_pk_add_f32 v[180:181], v[180:181], v[168:169]
    v_lshlrev_b32 v170, 16, v227
    v_and_b32 v171, s58, v227
    v_lshlrev_b32 v182, 16, v163
    v_and_b32 v183, s58, v163
    v_pk_add_f32 v[182:183], v[182:183], v[170:171]
    v_lshlrev_b32 v168, 16, v228
    v_and_b32 v169, s58, v228
    v_lshlrev_b32 v184, 16, v164
    v_and_b32 v185, s58, v164
    v_pk_add_f32 v[184:185], v[184:185], v[168:169]
    v_lshlrev_b32 v170, 16, v229
    v_and_b32 v171, s58, v229
    v_lshlrev_b32 v186, 16, v165
    v_and_b32 v187, s58, v165
    v_pk_add_f32 v[186:187], v[186:187], v[170:171]
    v_lshlrev_b32 v168, 16, v230
    v_and_b32 v169, s58, v230
    v_lshlrev_b32 v188, 16, v166
    v_and_b32 v189, s58, v166
    v_pk_add_f32 v[188:189], v[188:189], v[168:169]
    v_lshlrev_b32 v170, 16, v231
    v_and_b32 v171, s58, v231
    v_lshlrev_b32 v190, 16, v167
    v_and_b32 v191, s58, v167
    v_pk_add_f32 v[190:191], v[190:191], v[170:171]
    s_add_u32 s54, s18, 1
    s_and_b32 s54, s54, 3
    s_mul_i32 s54, s54, 12288
    s_add_u32 s54, s54, 0
    v_add_u32 v25, s54, v6
    s_add_u32 s54, s18, 2
    s_and_b32 s54, s54, 3
    s_mul_i32 s54, s54, 12288
    s_add_u32 s54, s54, 4096
    v_add_u32 v26, s54, v6
    s_add_u32 s54, s18, 3
    s_and_b32 s54, s54, 3
    s_mul_i32 s54, s54, 12288
    s_add_u32 s54, s54, 8192
    v_add_u32 v27, s54, v6
    s_mul_i32 s54, s18, 12288
    v_add_u32 v7, s54, v6
    s_lshl_b32 s53, s30, 2
    s_add_u32 s53, s53, s18
    s_lshl_b32 s53, s53, 14
    s_lshl_b32 s54, s29, 7
    s_add_u32 s53, s53, s54
    v_and_b32 v28, 15, v2
    v_lshlrev_b32 v28, 10, v28
    v_bfe_u32 v24, v2, 4, 1
    v_lshlrev_b32 v24, 5, v24
    v_add3_u32 v28, v28, v24, s53
    v_lshrrev_b32 v24, 5, v2
    v_lshlrev_b32 v24, 4, v24
    v_add_u32 v28, v28, v24
    s_lshl_b32 s54, s12, 5
    v_add_u32 v28, s54, v28
    v_xor_b32 v29, 64, v28
    s_waitcnt vmcnt(8)
    v_mfma_f32_16x16x32_bf16 v[192:195], a[0:3], v[32:35], 0
    v_mfma_f32_16x16x32_bf16 v[196:199], a[0:3], v[36:39], 0
    v_mfma_f32_16x16x32_bf16 v[200:203], a[0:3], v[40:43], 0
    v_mfma_f32_16x16x32_bf16 v[204:207], a[0:3], v[44:47], 0
    global_load_dwordx4 v[80:83], v8, s[48:49] offset:0
    global_load_dwordx4 v[84:87], v9, s[48:49] offset:0
    v_mfma_f32_16x16x32_bf16 v[208:211], a[4:7], v[32:35], 0
    v_mfma_f32_16x16x32_bf16 v[212:215], a[4:7], v[36:39], 0
    v_mfma_f32_16x16x32_bf16 v[216:219], a[4:7], v[40:43], 0
    v_mfma_f32_16x16x32_bf16 v[220:223], a[4:7], v[44:47], 0
    global_load_dwordx4 v[88:91], v10, s[48:49] offset:0
    global_load_dwordx4 v[92:95], v11, s[48:49] offset:0
    v_mfma_f32_16x16x32_bf16 v[224:227], a[8:11], v[32:35], 0
    v_mfma_f32_16x16x32_bf16 v[228:231], a[8:11], v[36:39], 0
    v_mfma_f32_16x16x32_bf16 v[232:235], a[8:11], v[40:43], 0
    v_mfma_f32_16x16x32_bf16 v[236:239], a[8:11], v[44:47], 0
    v_mfma_f32_16x16x32_bf16 v[240:243], a[12:15], v[32:35], 0
    v_mfma_f32_16x16x32_bf16 v[244:247], a[12:15], v[36:39], 0
    v_mfma_f32_16x16x32_bf16 v[248:251], a[12:15], v[40:43], 0
    v_mfma_f32_16x16x32_bf16 v[252:255], a[12:15], v[44:47], 0
    s_waitcnt vmcnt(8)
    v_mfma_f32_16x16x32_bf16 v[192:195], a[16:19], v[48:51], v[192:195]
    v_mfma_f32_16x16x32_bf16 v[196:199], a[16:19], v[52:55], v[196:199]
    v_mfma_f32_16x16x32_bf16 v[200:203], a[16:19], v[56:59], v[200:203]
    v_mfma_f32_16x16x32_bf16 v[204:207], a[16:19], v[60:63], v[204:207]
    global_load_dwordx4 v[96:99], v8, s[48:49] offset:1024
    global_load_dwordx4 v[100:103], v9, s[48:49] offset:1024
    v_mfma_f32_16x16x32_bf16 v[208:211], a[20:23], v[48:51], v[208:211]
    v_mfma_f32_16x16x32_bf16 v[212:215], a[20:23], v[52:55], v[212:215]
    v_mfma_f32_16x16x32_bf16 v[216:219], a[20:23], v[56:59], v[216:219]
    v_mfma_f32_16x16x32_bf16 v[220:223], a[20:23], v[60:63], v[220:223]
    global_load_dwordx4 v[104:107], v10, s[48:49] offset:1024
    global_load_dwordx4 v[108:111], v11, s[48:49] offset:1024
    v_mfma_f32_16x16x32_bf16 v[224:227], a[24:27], v[48:51], v[224:227]
    v_mfma_f32_16x16x32_bf16 v[228:231], a[24:27], v[52:55], v[228:231]
    v_mfma_f32_16x16x32_bf16 v[232:235], a[24:27], v[56:59], v[232:235]
    v_mfma_f32_16x16x32_bf16 v[236:239], a[24:27], v[60:63], v[236:239]
    v_mfma_f32_16x16x32_bf16 v[240:243], a[28:31], v[48:51], v[240:243]
    v_mfma_f32_16x16x32_bf16 v[244:247], a[28:31], v[52:55], v[244:247]
    v_mfma_f32_16x16x32_bf16 v[248:251], a[28:31], v[56:59], v[248:251]
    v_mfma_f32_16x16x32_bf16 v[252:255], a[28:31], v[60:63], v[252:255]
    s_waitcnt vmcnt(8)
    v_mfma_f32_16x16x32_bf16 v[192:195], a[32:35], v[64:67], v[192:195]
    v_mfma_f32_16x16x32_bf16 v[196:199], a[32:35], v[68:71], v[196:199]
    v_mfma_f32_16x16x32_bf16 v[200:203], a[32:35], v[72:75], v[200:203]
    v_mfma_f32_16x16x32_bf16 v[204:207], a[32:35], v[76:79], v[204:207]
    global_load_dwordx4 v[112:115], v8, s[48:49] offset:2048
    v_add_u32 v8, 3584, v8
    global_load_dwordx4 v[116:119], v9, s[48:49] offset:2048
    v_add_u32 v9, 3584, v9
    v_mfma_f32_16x16x32_bf16 v[208:211], a[36:39], v[64:67], v[208:211]
    v_mfma_f32_16x16x32_bf16 v[212:215], a[36:39], v[68:71], v[212:215]
    v_mfma_f32_16x16x32_bf16 v[216:219], a[36:39], v[72:75], v[216:219]
    v_mfma_f32_16x16x32_bf16 v[220:223], a[36:39], v[76:79], v[220:223]
    global_load_dwordx4 v[120:123], v10, s[48:49] offset:2048
    v_add_u32 v10, 3584, v10
    global_load_dwordx4 v[124:127], v11, s[48:49] offset:2048
    v_add_u32 v11, 3584, v11
    v_mfma_f32_16x16x32_bf16 v[224:227], a[40:43], v[64:67], v[224:227]
    v_mfma_f32_16x16x32_bf16 v[228:231], a[40:43], v[68:71], v[228:231]
    v_mfma_f32_16x16x32_bf16 v[232:235], a[40:43], v[72:75], v[232:235]
    v_mfma_f32_16x16x32_bf16 v[236:239], a[40:43], v[76:79], v[236:239]
    v_mfma_f32_16x16x32_bf16 v[240:243], a[44:47], v[64:67], v[240:243]
    v_mfma_f32_16x16x32_bf16 v[244:247], a[44:47], v[68:71], v[244:247]
    v_mfma_f32_16x16x32_bf16 v[248:251], a[44:47], v[72:75], v[248:251]
    v_mfma_f32_16x16x32_bf16 v[252:255], a[44:47], v[76:79], v[252:255]
    s_waitcnt vmcnt(8)
    v_mfma_f32_16x16x32_bf16 v[192:195], a[48:51], v[80:83], v[192:195]
    v_mfma_f32_16x16x32_bf16 v[196:199], a[48:51], v[84:87], v[196:199]
    v_mfma_f32_16x16x32_bf16 v[200:203], a[48:51], v[88:91], v[200:203]
    v_mfma_f32_16x16x32_bf16 v[204:207], a[48:51], v[92:95], v[204:207]
    global_load_dwordx4 v[128:131], v8, s[48:49] offset:0
    global_load_dwordx4 v[132:135], v9, s[48:49] offset:0
    v_mfma_f32_16x16x32_bf16 v[208:211], a[52:55], v[80:83], v[208:211]
    v_mfma_f32_16x16x32_bf16 v[212:215], a[52:55], v[84:87], v[212:215]
    v_mfma_f32_16x16x32_bf16 v[216:219], a[52:55], v[88:91], v[216:219]
    v_mfma_f32_16x16x32_bf16 v[220:223], a[52:55], v[92:95], v[220:223]
    global_load_dwordx4 v[136:139], v10, s[48:49] offset:0
    global_load_dwordx4 v[140:143], v11, s[48:49] offset:0
    v_mfma_f32_16x16x32_bf16 v[224:227], a[56:59], v[80:83], v[224:227]
    v_mfma_f32_16x16x32_bf16 v[228:231], a[56:59], v[84:87], v[228:231]
    v_mfma_f32_16x16x32_bf16 v[232:235], a[56:59], v[88:91], v[232:235]
    v_mfma_f32_16x16x32_bf16 v[236:239], a[56:59], v[92:95], v[236:239]
    v_mfma_f32_16x16x32_bf16 v[240:243], a[60:63], v[80:83], v[240:243]
    v_mfma_f32_16x16x32_bf16 v[244:247], a[60:63], v[84:87], v[244:247]
    v_mfma_f32_16x16x32_bf16 v[248:251], a[60:63], v[88:91], v[248:251]
    v_mfma_f32_16x16x32_bf16 v[252:255], a[60:63], v[92:95], v[252:255]
    s_waitcnt vmcnt(8)
    v_mfma_f32_16x16x32_bf16 v[192:195], a[64:67], v[96:99], v[192:195]
    v_mfma_f32_16x16x32_bf16 v[196:199], a[64:67], v[100:103], v[196:199]
    v_mfma_f32_16x16x32_bf16 v[200:203], a[64:67], v[104:107], v[200:203]
    v_mfma_f32_16x16x32_bf16 v[204:207], a[64:67], v[108:111], v[204:207]
    global_load_dwordx4 v[144:147], v8, s[48:49] offset:1024
    global_load_dwordx4 v[148:151], v9, s[48:49] offset:1024
    v_mfma_f32_16x16x32_bf16 v[208:211], a[68:71], v[96:99], v[208:211]
    v_mfma_f32_16x16x32_bf16 v[212:215], a[68:71], v[100:103], v[212:215]
    v_mfma_f32_16x16x32_bf16 v[216:219], a[68:71], v[104:107], v[216:219]
    v_mfma_f32_16x16x32_bf16 v[220:223], a[68:71], v[108:111], v[220:223]
    global_load_dwordx4 v[152:155], v10, s[48:49] offset:1024
    global_load_dwordx4 v[156:159], v11, s[48:49] offset:1024
    v_mfma_f32_16x16x32_bf16 v[224:227], a[72:75], v[96:99], v[224:227]
    v_mfma_f32_16x16x32_bf16 v[228:231], a[72:75], v[100:103], v[228:231]
    v_mfma_f32_16x16x32_bf16 v[232:235], a[72:75], v[104:107], v[232:235]
    v_mfma_f32_16x16x32_bf16 v[236:239], a[72:75], v[108:111], v[236:239]
    v_mfma_f32_16x16x32_bf16 v[240:243], a[76:79], v[96:99], v[240:243]
    v_mfma_f32_16x16x32_bf16 v[244:247], a[76:79], v[100:103], v[244:247]
    v_mfma_f32_16x16x32_bf16 v[248:251], a[76:79], v[104:107], v[248:251]
    v_mfma_f32_16x16x32_bf16 v[252:255], a[76:79], v[108:111], v[252:255]
    s_waitcnt vmcnt(8)
    v_mfma_f32_16x16x32_bf16 v[192:195], a[80:83], v[112:115], v[192:195]
    v_mfma_f32_16x16x32_bf16 v[196:199], a[80:83], v[116:119], v[196:199]
    v_mfma_f32_16x16x32_bf16 v[200:203], a[80:83], v[120:123], v[200:203]
    v_mfma_f32_16x16x32_bf16 v[204:207], a[80:83], v[124:127], v[204:207]
    global_load_dwordx4 v[32:35], v8, s[48:49] offset:2048
    v_add_u32 v8, 3584, v8
    global_load_dwordx4 v[36:39], v9, s[48:49] offset:2048
    v_add_u32 v9, 3584, v9
    v_mfma_f32_16x16x32_bf16 v[208:211], a[84:87], v[112:115], v[208:211]
    v_mfma_f32_16x16x32_bf16 v[212:215], a[84:87], v[116:119], v[212:215]
    v_mfma_f32_16x16x32_bf16 v[216:219], a[84:87], v[120:123], v[216:219]
    v_mfma_f32_16x16x32_bf16 v[220:223], a[84:87], v[124:127], v[220:223]
    global_load_dwordx4 v[40:43], v10, s[48:49] offset:2048
    v_add_u32 v10, 3584, v10
    global_load_dwordx4 v[44:47], v11, s[48:49] offset:2048
    v_add_u32 v11, 3584, v11
    v_mfma_f32_16x16x32_bf16 v[224:227], a[88:91], v[112:115], v[224:227]
    v_mfma_f32_16x16x32_bf16 v[228:231], a[88:91], v[116:119], v[228:231]
    v_mfma_f32_16x16x32_bf16 v[232:235], a[88:91], v[120:123], v[232:235]
    v_mfma_f32_16x16x32_bf16 v[236:239], a[88:91], v[124:127], v[236:239]
    v_mfma_f32_16x16x32_bf16 v[240:243], a[92:95], v[112:115], v[240:243]
    v_mfma_f32_16x16x32_bf16 v[244:247], a[92:95], v[116:119], v[244:247]
    v_mfma_f32_16x16x32_bf16 v[248:251], a[92:95], v[120:123], v[248:251]
    v_mfma_f32_16x16x32_bf16 v[252:255], a[92:95], v[124:127], v[252:255]
    s_waitcnt vmcnt(8)
    v_mfma_f32_16x16x32_bf16 v[192:195], a[96:99], v[128:131], v[192:195]
    v_mfma_f32_16x16x32_bf16 v[196:199], a[96:99], v[132:135], v[196:199]
    v_mfma_f32_16x16x32_bf16 v[200:203], a[96:99], v[136:139], v[200:203]
    v_mfma_f32_16x16x32_bf16 v[204:207], a[96:99], v[140:143], v[204:207]
    global_load_dwordx4 v[48:51], v8, s[48:49] offset:0
    global_load_dwordx4 v[52:55], v9, s[48:49] offset:0
    v_mfma_f32_16x16x32_bf16 v[208:211], a[100:103], v[128:131], v[208:211]
    v_mfma_f32_16x16x32_bf16 v[212:215], a[100:103], v[132:135], v[212:215]
    v_mfma_f32_16x16x32_bf16 v[216:219], a[100:103], v[136:139], v[216:219]
    v_mfma_f32_16x16x32_bf16 v[220:223], a[100:103], v[140:143], v[220:223]
    global_load_dwordx4 v[56:59], v10, s[48:49] offset:0
    global_load_dwordx4 v[60:63], v11, s[48:49] offset:0
    v_mfma_f32_16x16x32_bf16 v[224:227], a[104:107], v[128:131], v[224:227]
    v_mfma_f32_16x16x32_bf16 v[228:231], a[104:107], v[132:135], v[228:231]
    v_mfma_f32_16x16x32_bf16 v[232:235], a[104:107], v[136:139], v[232:235]
    v_mfma_f32_16x16x32_bf16 v[236:239], a[104:107], v[140:143], v[236:239]
    v_mfma_f32_16x16x32_bf16 v[240:243], a[108:111], v[128:131], v[240:243]
    v_mfma_f32_16x16x32_bf16 v[244:247], a[108:111], v[132:135], v[244:247]
    v_mfma_f32_16x16x32_bf16 v[248:251], a[108:111], v[136:139], v[248:251]
    v_mfma_f32_16x16x32_bf16 v[252:255], a[108:111], v[140:143], v[252:255]
    s_waitcnt vmcnt(8)
    v_mfma_f32_16x16x32_bf16 v[192:195], a[112:115], v[144:147], v[192:195]
    v_mfma_f32_16x16x32_bf16 v[196:199], a[112:115], v[148:151], v[196:199]
    v_mfma_f32_16x16x32_bf16 v[200:203], a[112:115], v[152:155], v[200:203]
    v_mfma_f32_16x16x32_bf16 v[204:207], a[112:115], v[156:159], v[204:207]
    global_load_dwordx4 v[64:67], v8, s[48:49] offset:1024
    global_load_dwordx4 v[68:71], v9, s[48:49] offset:1024
    v_mfma_f32_16x16x32_bf16 v[208:211], a[116:119], v[144:147], v[208:211]
    v_mfma_f32_16x16x32_bf16 v[212:215], a[116:119], v[148:151], v[212:215]
    v_mfma_f32_16x16x32_bf16 v[216:219], a[116:119], v[152:155], v[216:219]
    v_mfma_f32_16x16x32_bf16 v[220:223], a[116:119], v[156:159], v[220:223]
    global_load_dwordx4 v[72:75], v10, s[48:49] offset:1024
    global_load_dwordx4 v[76:79], v11, s[48:49] offset:1024
    v_mfma_f32_16x16x32_bf16 v[224:227], a[120:123], v[144:147], v[224:227]
    v_mfma_f32_16x16x32_bf16 v[228:231], a[120:123], v[148:151], v[228:231]
    v_mfma_f32_16x16x32_bf16 v[232:235], a[120:123], v[152:155], v[232:235]
    v_mfma_f32_16x16x32_bf16 v[236:239], a[120:123], v[156:159], v[236:239]
    v_mfma_f32_16x16x32_bf16 v[240:243], a[124:127], v[144:147], v[240:243]
    v_mfma_f32_16x16x32_bf16 v[244:247], a[124:127], v[148:151], v[244:247]
    v_mfma_f32_16x16x32_bf16 v[248:251], a[124:127], v[152:155], v[248:251]
    v_mfma_f32_16x16x32_bf16 v[252:255], a[124:127], v[156:159], v[252:255]
    s_waitcnt vmcnt(8)
    v_mfma_f32_16x16x32_bf16 v[192:195], a[128:131], v[32:35], v[192:195]
    v_mfma_f32_16x16x32_bf16 v[196:199], a[128:131], v[36:39], v[196:199]
    v_mfma_f32_16x16x32_bf16 v[200:203], a[128:131], v[40:43], v[200:203]
    v_mfma_f32_16x16x32_bf16 v[204:207], a[128:131], v[44:47], v[204:207]
    global_load_dwordx4 v[80:83], v8, s[48:49] offset:2048
    global_load_dwordx4 v[84:87], v9, s[48:49] offset:2048
    v_mfma_f32_16x16x32_bf16 v[208:211], a[132:135], v[32:35], v[208:211]
    v_mfma_f32_16x16x32_bf16 v[212:215], a[132:135], v[36:39], v[212:215]
    v_mfma_f32_16x16x32_bf16 v[216:219], a[132:135], v[40:43], v[216:219]
    v_mfma_f32_16x16x32_bf16 v[220:223], a[132:135], v[44:47], v[220:223]
    global_load_dwordx4 v[88:91], v10, s[48:49] offset:2048
    global_load_dwordx4 v[92:95], v11, s[48:49] offset:2048
    v_mfma_f32_16x16x32_bf16 v[224:227], a[136:139], v[32:35], v[224:227]
    v_mfma_f32_16x16x32_bf16 v[228:231], a[136:139], v[36:39], v[228:231]
    v_mfma_f32_16x16x32_bf16 v[232:235], a[136:139], v[40:43], v[232:235]
    v_mfma_f32_16x16x32_bf16 v[236:239], a[136:139], v[44:47], v[236:239]
    v_mfma_f32_16x16x32_bf16 v[240:243], a[140:143], v[32:35], v[240:243]
    v_mfma_f32_16x16x32_bf16 v[244:247], a[140:143], v[36:39], v[244:247]
    v_mfma_f32_16x16x32_bf16 v[248:251], a[140:143], v[40:43], v[248:251]
    v_mfma_f32_16x16x32_bf16 v[252:255], a[140:143], v[44:47], v[252:255]
    s_waitcnt vmcnt(8)
    v_mfma_f32_16x16x32_bf16 v[192:195], a[144:147], v[48:51], v[192:195]
    v_mfma_f32_16x16x32_bf16 v[196:199], a[144:147], v[52:55], v[196:199]
    v_mfma_f32_16x16x32_bf16 v[200:203], a[144:147], v[56:59], v[200:203]
    v_mfma_f32_16x16x32_bf16 v[204:207], a[144:147], v[60:63], v[204:207]
    global_load_dwordx4 v[96:99], v12, s[48:49]
    v_add_u32 v12, 7168, v12
    global_load_dwordx4 v[100:103], v13, s[48:49]
    v_add_u32 v13, 7168, v13
    v_mfma_f32_16x16x32_bf16 v[208:211], a[148:151], v[48:51], v[208:211]
    v_mfma_f32_16x16x32_bf16 v[212:215], a[148:151], v[52:55], v[212:215]
    v_mfma_f32_16x16x32_bf16 v[216:219], a[148:151], v[56:59], v[216:219]
    v_mfma_f32_16x16x32_bf16 v[220:223], a[148:151], v[60:63], v[220:223]
    global_load_dwordx4 v[104:107], v14, s[48:49]
    v_add_u32 v14, 7168, v14
    global_load_dwordx4 v[108:111], v15, s[48:49]
    v_add_u32 v15, 7168, v15
    v_mfma_f32_16x16x32_bf16 v[224:227], a[152:155], v[48:51], v[224:227]
    v_mfma_f32_16x16x32_bf16 v[228:231], a[152:155], v[52:55], v[228:231]
    v_mfma_f32_16x16x32_bf16 v[232:235], a[152:155], v[56:59], v[232:235]
    v_mfma_f32_16x16x32_bf16 v[236:239], a[152:155], v[60:63], v[236:239]
    v_mfma_f32_16x16x32_bf16 v[240:243], a[156:159], v[48:51], v[240:243]
    v_mfma_f32_16x16x32_bf16 v[244:247], a[156:159], v[52:55], v[244:247]
    v_mfma_f32_16x16x32_bf16 v[248:251], a[156:159], v[56:59], v[248:251]
    v_mfma_f32_16x16x32_bf16 v[252:255], a[156:159], v[60:63], v[252:255]
    s_waitcnt vmcnt(8)
    v_mfma_f32_16x16x32_bf16 v[192:195], a[160:163], v[64:67], v[192:195]
    v_mfma_f32_16x16x32_bf16 v[196:199], a[160:163], v[68:71], v[196:199]
    v_mfma_f32_16x16x32_bf16 v[200:203], a[160:163], v[72:75], v[200:203]
    v_mfma_f32_16x16x32_bf16 v[204:207], a[160:163], v[76:79], v[204:207]
    global_load_dwordx4 v[112:115], v12, s[48:49]
    global_load_dwordx4 v[116:119], v13, s[48:49]
    v_mfma_f32_16x16x32_bf16 v[208:211], a[164:167], v[64:67], v[208:211]
    v_mfma_f32_16x16x32_bf16 v[212:215], a[164:167], v[68:71], v[212:215]
    v_mfma_f32_16x16x32_bf16 v[216:219], a[164:167], v[72:75], v[216:219]
    v_mfma_f32_16x16x32_bf16 v[220:223], a[164:167], v[76:79], v[220:223]
    global_load_dwordx4 v[120:123], v14, s[48:49]
    global_load_dwordx4 v[124:127], v15, s[48:49]
    v_mfma_f32_16x16x32_bf16 v[224:227], a[168:171], v[64:67], v[224:227]
    v_mfma_f32_16x16x32_bf16 v[228:231], a[168:171], v[68:71], v[228:231]
    v_mfma_f32_16x16x32_bf16 v[232:235], a[168:171], v[72:75], v[232:235]
    v_mfma_f32_16x16x32_bf16 v[236:239], a[168:171], v[76:79], v[236:239]
    v_mfma_f32_16x16x32_bf16 v[240:243], a[172:175], v[64:67], v[240:243]
    v_mfma_f32_16x16x32_bf16 v[244:247], a[172:175], v[68:71], v[244:247]
    v_mfma_f32_16x16x32_bf16 v[248:251], a[172:175], v[72:75], v[248:251]
    v_mfma_f32_16x16x32_bf16 v[252:255], a[172:175], v[76:79], v[252:255]
    s_waitcnt vmcnt(8)
    v_mfma_f32_16x16x32_bf16 v[192:195], a[176:179], v[80:83], v[192:195]
    v_mfma_f32_16x16x32_bf16 v[196:199], a[176:179], v[84:87], v[196:199]
    v_mfma_f32_16x16x32_bf16 v[200:203], a[176:179], v[88:91], v[200:203]
    v_mfma_f32_16x16x32_bf16 v[204:207], a[176:179], v[92:95], v[204:207]
    v_mfma_f32_16x16x32_bf16 v[208:211], a[180:183], v[80:83], v[208:211]
    v_mfma_f32_16x16x32_bf16 v[212:215], a[180:183], v[84:87], v[212:215]
    v_mfma_f32_16x16x32_bf16 v[216:219], a[180:183], v[88:91], v[216:219]
    v_mfma_f32_16x16x32_bf16 v[220:223], a[180:183], v[92:95], v[220:223]
    v_mfma_f32_16x16x32_bf16 v[224:227], a[184:187], v[80:83], v[224:227]
    v_mfma_f32_16x16x32_bf16 v[228:231], a[184:187], v[84:87], v[228:231]
    v_mfma_f32_16x16x32_bf16 v[232:235], a[184:187], v[88:91], v[232:235]
    v_mfma_f32_16x16x32_bf16 v[236:239], a[184:187], v[92:95], v[236:239]
    v_mfma_f32_16x16x32_bf16 v[240:243], a[188:191], v[80:83], v[240:243]
    v_mfma_f32_16x16x32_bf16 v[244:247], a[188:191], v[84:87], v[244:247]
    v_mfma_f32_16x16x32_bf16 v[248:251], a[188:191], v[88:91], v[248:251]
    v_mfma_f32_16x16x32_bf16 v[252:255], a[188:191], v[92:95], v[252:255]
    s_waitcnt vmcnt(4)
    v_mfma_f32_16x16x32_bf16 v[192:195], a[192:195], v[96:99], v[192:195]
    v_mfma_f32_16x16x32_bf16 v[196:199], a[192:195], v[100:103], v[196:199]
    v_mfma_f32_16x16x32_bf16 v[200:203], a[192:195], v[104:107], v[200:203]
    v_mfma_f32_16x16x32_bf16 v[204:207], a[192:195], v[108:111], v[204:207]
    v_mfma_f32_16x16x32_bf16 v[208:211], a[196:199], v[96:99], v[208:211]
    v_mfma_f32_16x16x32_bf16 v[212:215], a[196:199], v[100:103], v[212:215]
    v_mfma_f32_16x16x32_bf16 v[216:219], a[196:199], v[104:107], v[216:219]
    v_mfma_f32_16x16x32_bf16 v[220:223], a[196:199], v[108:111], v[220:223]
    v_mfma_f32_16x16x32_bf16 v[224:227], a[200:203], v[96:99], v[224:227]
    v_mfma_f32_16x16x32_bf16 v[228:231], a[200:203], v[100:103], v[228:231]
    v_mfma_f32_16x16x32_bf16 v[232:235], a[200:203], v[104:107], v[232:235]
    v_mfma_f32_16x16x32_bf16 v[236:239], a[200:203], v[108:111], v[236:239]
    v_mfma_f32_16x16x32_bf16 v[240:243], a[204:207], v[96:99], v[240:243]
    v_mfma_f32_16x16x32_bf16 v[244:247], a[204:207], v[100:103], v[244:247]
    v_mfma_f32_16x16x32_bf16 v[248:251], a[204:207], v[104:107], v[248:251]
    v_mfma_f32_16x16x32_bf16 v[252:255], a[204:207], v[108:111], v[252:255]
    s_waitcnt vmcnt(0)
    v_mfma_f32_16x16x32_bf16 v[196:199], a[208:211], v[116:119], v[196:199]
    v_mfma_f32_16x16x32_bf16 v[212:215], a[212:215], v[116:119], v[212:215]
    v_mfma_f32_16x16x32_bf16 v[228:231], a[216:219], v[116:119], v[228:231]
    v_mfma_f32_16x16x32_bf16 v[244:247], a[220:223], v[116:119], v[244:247]
    v_mfma_f32_16x16x32_bf16 v[200:203], a[208:211], v[120:123], v[200:203]
    ds_write_b128 v25, v[196:199] offset:0
    v_mfma_f32_16x16x32_bf16 v[216:219], a[212:215], v[120:123], v[216:219]
    ds_write_b128 v25, v[212:215] offset:1024
    v_mfma_f32_16x16x32_bf16 v[232:235], a[216:219], v[120:123], v[232:235]
    ds_write_b128 v25, v[228:231] offset:2048
    v_mfma_f32_16x16x32_bf16 v[248:251], a[220:223], v[120:123], v[248:251]
    ds_write_b128 v25, v[244:247] offset:3072
    v_mfma_f32_16x16x32_bf16 v[204:207], a[208:211], v[124:127], v[204:207]
    ds_write_b128 v26, v[200:203] offset:0
    v_mfma_f32_16x16x32_bf16 v[220:223], a[212:215], v[124:127], v[220:223]
    ds_write_b128 v26, v[216:219] offset:1024
    v_mfma_f32_16x16x32_bf16 v[236:239], a[216:219], v[124:127], v[236:239]
    ds_write_b128 v26, v[232:235] offset:2048
    v_mfma_f32_16x16x32_bf16 v[252:255], a[220:223], v[124:127], v[252:255]
    ds_write_b128 v26, v[248:251] offset:3072
    v_mfma_f32_16x16x32_bf16 v[192:195], a[208:211], v[112:115], v[192:195]
    ds_write_b128 v27, v[204:207] offset:0
    v_mfma_f32_16x16x32_bf16 v[208:211], a[212:215], v[112:115], v[208:211]
    ds_write_b128 v27, v[220:223] offset:1024
    v_mfma_f32_16x16x32_bf16 v[224:227], a[216:219], v[112:115], v[224:227]
    ds_write_b128 v27, v[236:239] offset:2048
    v_mfma_f32_16x16x32_bf16 v[240:243], a[220:223], v[112:115], v[240:243]
    ds_write_b128 v27, v[252:255] offset:3072
    s_nop 7
    v_pk_add_f32 v[176:177], v[176:177], v[192:193]
    v_pk_add_f32 v[178:179], v[178:179], v[194:195]
    v_pk_add_f32 v[180:181], v[180:181], v[208:209]
    v_pk_add_f32 v[182:183], v[182:183], v[210:211]
    v_pk_add_f32 v[184:185], v[184:185], v[224:225]
    v_pk_add_f32 v[186:187], v[186:187], v[226:227]
    v_pk_add_f32 v[188:189], v[188:189], v[240:241]
    v_pk_add_f32 v[190:191], v[190:191], v[242:243]
    s_waitcnt lgkmcnt(0)
    s_barrier
    ds_read_b128 v[64:67], v7 offset:0
    ds_read_b128 v[80:83], v7 offset:4096
    ds_read_b128 v[96:99], v7 offset:8192
    ds_read_b128 v[68:71], v7 offset:1024
    ds_read_b128 v[84:87], v7 offset:5120
    ds_read_b128 v[100:103], v7 offset:9216
    ds_read_b128 v[72:75], v7 offset:2048
    ds_read_b128 v[88:91], v7 offset:6144
    ds_read_b128 v[104:107], v7 offset:10240
    ds_read_b128 v[76:79], v7 offset:3072
    ds_read_b128 v[92:95], v7 offset:7168
    ds_read_b128 v[108:111], v7 offset:11264
    s_waitcnt lgkmcnt(9)
    v_pk_add_f32 v[64:65], v[64:65], v[80:81]
    v_pk_add_f32 v[66:67], v[66:67], v[82:83]
    v_pk_add_f32 v[96:97], v[96:97], v[176:177]
    v_pk_add_f32 v[98:99], v[98:99], v[178:179]
    v_pk_add_f32 v[64:65], v[64:65], v[96:97]
    v_pk_add_f32 v[66:67], v[66:67], v[98:99]
    v_cvt_pk_bf16_f32 v144, v64, v65
    v_cvt_pk_bf16_f32 v145, v66, v67
    s_waitcnt lgkmcnt(6)
    v_pk_add_f32 v[68:69], v[68:69], v[84:85]
    v_pk_add_f32 v[70:71], v[70:71], v[86:87]
    v_pk_add_f32 v[100:101], v[100:101], v[180:181]
    v_pk_add_f32 v[102:103], v[102:103], v[182:183]
    v_pk_add_f32 v[68:69], v[68:69], v[100:101]
    v_pk_add_f32 v[70:71], v[70:71], v[102:103]
    v_cvt_pk_bf16_f32 v146, v68, v69
    v_cvt_pk_bf16_f32 v147, v70, v71
    s_nop 1
    v_permlane16_swap_b32 v144, v146
    v_permlane16_swap_b32 v145, v147
    global_store_dwordx4 v28, v[144:147], s[44:45]
    s_waitcnt lgkmcnt(3)
    v_pk_add_f32 v[72:73], v[72:73], v[88:89]
    v_pk_add_f32 v[74:75], v[74:75], v[90:91]
    v_pk_add_f32 v[104:105], v[104:105], v[184:185]
    v_pk_add_f32 v[106:107], v[106:107], v[186:187]
    v_pk_add_f32 v[72:73], v[72:73], v[104:105]
    v_pk_add_f32 v[74:75], v[74:75], v[106:107]
    v_cvt_pk_bf16_f32 v148, v72, v73
    v_cvt_pk_bf16_f32 v149, v74, v75
    s_waitcnt lgkmcnt(0)
    v_pk_add_f32 v[76:77], v[76:77], v[92:93]
    v_pk_add_f32 v[78:79], v[78:79], v[94:95]
    v_pk_add_f32 v[108:109], v[108:109], v[188:189]
    v_pk_add_f32 v[110:111], v[110:111], v[190:191]
    v_pk_add_f32 v[76:77], v[76:77], v[108:109]
    v_pk_add_f32 v[78:79], v[78:79], v[110:111]
    v_cvt_pk_bf16_f32 v150, v76, v77
    v_cvt_pk_bf16_f32 v151, v78, v79
    s_nop 1
    v_permlane16_swap_b32 v148, v150
    v_permlane16_swap_b32 v149, v151
    global_store_dwordx4 v29, v[148:151], s[44:45]
Lexit_1:
Lkernel_end:
    s_endpgm
.section .rodata,"a"
.p2align 6
.amdhsa_kernel sequential_preLN__ssm_conv_s4d__dense_activation_gelu__prompt_kernel
  .amdhsa_next_free_vgpr 512
  .amdhsa_next_free_sgpr 102
  .amdhsa_accum_offset 256
  .amdhsa_group_segment_fixed_size 0
  .amdhsa_kernarg_size 120
  .amdhsa_user_sgpr_count 2
  .amdhsa_user_sgpr_kernarg_segment_ptr 1
  .amdhsa_system_sgpr_workgroup_id_x 1
  .amdhsa_float_denorm_mode_32 3
.end_amdhsa_kernel
```
